```python
import torch

def _softmax(x, axis=-1):
    return torch.softmax(x, dim=axis)
def _gelu(x):
    return torch.nn.functional.gelu(x, approximate="tanh")
def _silu(x):
    return torch.nn.functional.silu(x)
def _sigmoid(x):
    return torch.sigmoid(x)
def _layernorm(x, axis=-1, eps=1e-5):
    m = x.mean(dim=axis, keepdim=True)
    v = x.var(dim=axis, keepdim=True, unbiased=False)
    return (x - m) / torch.sqrt(v + eps)
def _scatter_add(tgt, idx, src, axis=0):
    return tgt.clone().index_add_(axis, idx, src)
def _segment_sum(src, seg, n):
    out = torch.zeros((n,) + src.shape[1:], dtype=src.dtype)
    return out.index_add_(0, seg, src)
def _pad(x, pw):
    flat = tuple(v for pair in reversed(pw) for v in pair)
    return torch.nn.functional.pad(x, flat)

kernel_name = 'standalone__dense_activation_gelu__prompt'

def setup_inputs():

    _w = (lambda a: (lambda t: t.to(torch.bfloat16) if t.is_floating_point() else t)(torch.as_tensor(a)))
    B, S, D, F = 1, 2048, 640, 1728
    return {
        "x": _w((lambda *s: torch.randn(*s, dtype=torch.bfloat16) * 0.05)(B, S, D)),
        "w1": _w((lambda *s: torch.randn(*s, dtype=torch.bfloat16) * 3.2)(D, F) * (D ** -0.5)),
        "b1": _w((lambda *s: torch.randn(*s, dtype=torch.bfloat16) * 3.2)(F) * 0.01),
        "w2": _w((lambda *s: torch.randn(*s, dtype=torch.bfloat16) * 0.05)(F, D) * (F ** -0.5)),
        "b2": _w((lambda *s: torch.randn(*s, dtype=torch.bfloat16) * 0.1)(D) * 0.01),
    }

def reference(x, w1, b1, w2, b2):
    h = torch.einsum("bsd,df->bsf", x, w1) + b1
    h = _gelu(h)
    return torch.einsum("bsf,fd->bsd", h, w2) + b2
```

```asm
; @launch grid=(256,1,1) block=(256,1,1) lds=163840
.amdgcn_target "amdgcn-amd-amdhsa--gfx950"
.text
.globl standalone__dense_activation_gelu__prompt_kernel
.p2align 12
.p2align 8
.type standalone__dense_activation_gelu__prompt_kernel,@function
standalone__dense_activation_gelu__prompt_kernel:
    s_cmp_ge_u32 s2, 256
    s_cbranch_scc1 L_end
    s_load_dwordx16 s[40:55], s[0:1], 0
    v_lshrrev_b32 v2, 6, v0
    v_and_b32 v1, 63, v0
    v_readfirstlane_b32 s3, v2
    s_lshr_b32 s5, s2, 3
    s_and_b32 s4, s2, 7
    s_getpc_b64 s[76:77]
L_pc:
    s_and_b32 s64, s5, 7
    s_lshl_b32 s64, s64, 5
    v_min_u32 v3, 31, v0
    v_add_lshl_u32 v3, v3, s64, 7
    v_min_u32 v3, L_code_end-L_pc-4, v3
    global_load_dword v30, v3, s[76:77]
    s_mov_b32 s63, 0
    s_cmp_ge_u32 s5, 28
    s_cbranch_scc1 L_helper
    s_mul_i32 s66, s5, 37
    s_lshr_b32 s66, s66, 8
    s_mul_i32 s67, s66, 7
    s_sub_u32 s67, s5, s67
    s_lshr_b32 s64, s4, 1
    s_and_b32 s65, s4, 1
    s_lshl_b32 s56, s64, 2
    s_add_u32 s56, s56, s66
    s_mul_i32 s57, s65, 7
    s_add_u32 s57, s57, s67
    s_mul_i32 s61, s65, 5
    s_add_u32 s61, s61, s64
    s_add_u32 s66, s66, s67
    s_and_b32 s6, s66, 3
    s_mul_i32 s92, s56, 163840
    s_mul_i32 s65, s3, 20480
    s_add_u32 s92, s92, s65
    s_lshl_b32 s93, s57, 8
    s_mul_i32 s65, s3, 55296
    s_add_u32 s93, s93, s65
    s_and_b32 s74, s6, 15
    s_lshr_b64 s[6:7], s[6:7], 4
    s_add_u32 s74, s74, s61
    s_cmp_ge_u32 s74, 10
    s_cselect_b32 s75, 10, 0
    s_sub_u32 s74, s74, s75
    s_lshl_b32 s75, s74, 7
    s_add_u32 s70, s92, s75
    s_mul_i32 s75, s74, 221184
    s_add_u32 s71, s93, s75
    s_lshl_b32 s68, s3, 11
    s_lshl_b32 s69, s3, 12
    s_add_u32 s69, s69, 32768
    v_lshrrev_b32 v2, 3, v1
    v_mul_u32_u24 v7, 1280, v2
    v_and_b32 v3, 7, v1
    v_lshrrev_b32 v4, 4, v1
    v_xor_b32 v3, v3, v4
    v_xor_b32 v5, 4, v3
    v_lshl_add_u32 v16, v3, 4, v7
    v_lshl_add_u32 v17, v5, 4, v7
    v_add_u32 v17, 9216, v17
    v_mul_u32_u24 v2, 3456, v4
    v_and_b32 v3, 15, v1
    v_lshlrev_b32 v5, 2, v4
    v_xor_b32 v3, v3, v5
    v_lshl_add_u32 v18, v3, 4, v2
    s_cmp_eq_u32 s57, 13
    s_cselect_b32 s64, 8, 16
    v_mov_b32 v5, 1073741824
    v_cmp_gt_u32 vcc, s64, v3
    s_mov_b32 s10, 2621440
    s_mov_b32 s11, 0x20000
    v_cndmask_b32 v18, v5, v18, vcc
    v_add_u32 v19, 12800, v18
    v_xor_b32 v21, 32, v18
    v_add_u32 v20, 25600, v21
    v_add_u32 v21, 38400, v21
    s_mov_b32 s14, 2211840
    s_mov_b32 s15, 0x20000
    s_mov_b32 m0, s68
    s_waitcnt lgkmcnt(0)
    s_mov_b64 s[8:9], s[40:41]
    s_mov_b64 s[12:13], s[42:43]
    buffer_load_dwordx4 v16, s[8:11], s70 offen offset:0  lds
    buffer_load_dwordx4 v17, s[8:11], s70 offen offset:1024  lds
    s_add_u32 m0, s69, 0
    s_nop 0
    buffer_load_dwordx4 v18, s[12:15], s71 offen offset:0  lds
    buffer_load_dwordx4 v19, s[12:15], s71 offen offset:1024  lds
    buffer_load_dwordx4 v20, s[12:15], s71 offen offset:2048  lds
    buffer_load_dwordx4 v21, s[12:15], s71 offen offset:3072  lds
    s_bitcmp1_b32 s66, 0
    s_mov_b32 s64, 0x65321840
    s_cselect_b32 s64, 0x64320951, s64
    s_mov_b32 s65, 0x75431062
    s_cselect_b32 s65, 0x65421073, s65
    s_mov_b32 s67, 0x97
    s_cselect_b32 s67, 0x87, s67
    s_bitcmp1_b32 s66, 1
    s_cselect_b32 s76, s65, s64
    s_cselect_b32 s77, 0x98, s67
    s_lshr_b64 s[6:7], s[76:77], 4
    s_and_b32 s74, s6, 15
    s_lshr_b64 s[6:7], s[6:7], 4
    s_add_u32 s74, s74, s61
    s_cmp_ge_u32 s74, 10
    s_cselect_b32 s75, 10, 0
    s_sub_u32 s74, s74, s75
    s_lshl_b32 s75, s74, 7
    s_add_u32 s72, s92, s75
    s_mul_i32 s75, s74, 221184
    s_add_u32 s73, s93, s75
    s_add_u32 m0, s68, 8192
    s_nop 0
    buffer_load_dwordx4 v16, s[8:11], s72 offen offset:0  lds
    buffer_load_dwordx4 v17, s[8:11], s72 offen offset:1024  lds
    s_add_u32 m0, s69, 16384
    s_nop 0
    buffer_load_dwordx4 v18, s[12:15], s73 offen offset:0  lds
    buffer_load_dwordx4 v19, s[12:15], s73 offen offset:1024  lds
    buffer_load_dwordx4 v20, s[12:15], s73 offen offset:2048  lds
    buffer_load_dwordx4 v21, s[12:15], s73 offen offset:3072  lds
    s_mov_b64 s[28:29], s[44:45]
    s_mov_b32 s30, 3456
    s_mov_b32 s31, 0x20000
    s_mov_b64 s[24:25], s[46:47]
    s_mov_b32 s26, 2211840
    s_mov_b32 s27, 0x20000
    s_mov_b64 s[32:33], s[48:49]
    s_mov_b32 s34, 1280
    s_mov_b32 s35, 0x20000
    s_mov_b64 s[20:21], s[50:51]
    s_mov_b32 s22, 2621440
    s_mov_b32 s23, 0x20000
    s_mov_b64 s[36:37], s[52:53]
    s_mov_b32 s38, 256
    s_mov_b32 s39, 0x20000
    s_mov_b64 s[16:17], s[54:55]
    s_mov_b32 s18, 16777216
    s_mov_b32 s19, 0x20000
    s_lshr_b32 s64, s4, 1
    s_mul_i32 s65, s64, 55
    s_add_u32 s65, s65, 1
    s_lshr_b32 s65, s65, 1
    s_add_u32 s65, s65, s5
    s_and_b32 s64, s64, 1
    s_cmp_eq_u32 s5, 27
    s_cselect_b32 s80, s64, 0
    s_mul_i32 s58, s65, 205
    s_lshr_b32 s58, s58, 10
    s_mul_i32 s64, s58, 5
    s_sub_u32 s59, s65, s64
    s_and_b32 s64, s4, 1
    s_mul_i32 s64, s64, 5
    s_add_u32 s59, s59, s64
    v_and_b32 v3, 7, v1
    v_lshlrev_b32 v4, 1, v4
    v_xor_b32 v3, v3, v4
    v_lshl_add_u32 v200, v3, 4, v7
    s_lshl_b32 s64, s80, 30
    v_or_b32 v200, s64, v200
    v_add_u32 v201, 9216, v200
    v_add_u32 v202, 18432, v200
    v_add_u32 v203, 27648, v200
    s_mul_i32 s78, s3, 573440
    s_lshl_b32 s64, s59, 7
    s_add_u32 s78, s78, s64
    s_sub_u32 s78, s78, 40960
    v_lshrrev_b32 v4, 2, v1
    v_bfe_u32 v3, v4, 1, 2
    v_and_b32 v7, 3, v1
    v_lshlrev_b32 v7, 3, v7
    v_lshl_add_u32 v4, v4, 7, v7
    s_lshl_b32 s64, s3, 12
    v_add_u32 v4, s64, v4
    v_xor_b32 v7, 0, v3
    v_lshl_add_u32 v204, v7, 5, v4
    v_add_u32 v208, 0x10000, v204
    v_add_u32 v212, 0x20000, v204
    v_xor_b32 v7, 1, v3
    v_lshl_add_u32 v205, v7, 5, v4
    v_add_u32 v209, 0x10000, v205
    v_add_u32 v213, 0x20000, v205
    v_xor_b32 v7, 2, v3
    v_lshl_add_u32 v206, v7, 5, v4
    v_add_u32 v210, 0x10000, v206
    v_add_u32 v214, 0x20000, v206
    v_xor_b32 v7, 3, v3
    v_lshl_add_u32 v207, v7, 5, v4
    v_add_u32 v211, 0x10000, v207
    v_add_u32 v215, 0x20000, v207
    s_lshl_b32 s66, s57, 2
    s_add_u32 s66, s66, s3
    s_cmp_lt_u32 s66, 54
    s_cselect_b32 s67, 0, 1073741824
    s_mul_i32 s64, s56, 443392
    s_lshl_b32 s65, s66, 10
    s_add_u32 s64, s64, s65
    s_add_u32 s64, s64, s67
    s_add_u32 s82, s64, 1048576
    s_add_u32 s83, s64, 1270272
    s_lshl_b32 s64, s56, 7
    s_add_u32 s64, s64, s66
    s_lshl_b32 s64, s64, 7
    s_add_u32 s64, s64, s67
    s_add_u32 s62, s64, 65536
    s_add_u32 s88, s64, 73728
    v_and_b32 v2, 15, v1
    v_lshlrev_b32 v3, 7, v2
    v_lshrrev_b32 v2, 1, v2
    v_lshrrev_b32 v6, 4, v1
    v_xor_b32 v2, v2, v6
    v_xor_b32 v4, 0, v2
    v_lshl_add_u32 v22, v4, 4, v3
    v_add_u32 v24, 98304, v22
    v_xor_b32 v4, 4, v2
    v_lshl_add_u32 v23, v4, 4, v3
    v_add_u32 v25, 98304, v23
    v_bfe_u32 v2, v1, 2, 2
    v_lshl_add_u32 v3, v6, 3, v2
    v_lshlrev_b32 v3, 8, v3
    v_xor_b32 v2, s3, v2
    v_lshl_add_u32 v3, v2, 6, v3
    v_bfe_u32 v2, v1, 4, 1
    v_lshl_add_u32 v3, v2, 5, v3
    v_and_b32 v4, 3, v1
    v_lshl_add_u32 v3, v4, 3, v3
    v_add_u32 v26, 32768, v3
    v_xor_b32 v27, 32, v26
    v_mov_b32 v8, 0xc0135761
    v_mov_b32 v9, 0xc0135761
    s_mov_b32 s86, 0xbdd2d3e8
    s_mov_b32 s87, 0xbdd2d3e8
    v_mov_b32 v32, 0x3f80
    v_mov_b32 v33, 0
    v_mov_b32 v61, 0
    v_mov_b32 v65, 0
    v_mov_b32 v34, 0
    v_mov_b32 v62, 0
    v_mov_b32 v66, 0
    v_mov_b32 v35, 0
    v_mov_b32 v63, 0
    v_mov_b32 v67, 0
    s_lshl_b32 s66, s66, 6
    v_lshlrev_b32 v7, 1, v1
    v_cmp_gt_u32 vcc, 16, v1
    v_lshlrev_b32 v10, 4, v1
    s_cmp_eq_u32 s3, 3
    v_cndmask_b32 v7, v5, v7, vcc
    s_cselect_b32 s64, 1073741824, 0
    v_or_b32 v11, s64, v10
    s_mul_i32 s64, s3, 14
    v_and_b32 v2, 15, v1
    v_min_u32 v2, 13, v2
    v_add_u32 v2, s64, v2
    v_min_u32 v2, 53, v2
    s_mul_i32 s64, s58, 3
    v_bfe_u32 v3, v1, 4, 1
    v_lshl_add_u32 v3, v3, 1, s64
    v_lshrrev_b32 v3, 2, v3
    v_min_u32 v3, 15, v3
    v_lshl_add_u32 v2, v3, 7, v2
    v_lshlrev_b32 v2, 7, v2
    v_add_u32 v13, 65536, v2
    v_add_u32 v14, 73728, v2
    v_and_b32 v2, 15, v1
    v_lshrrev_b32 v3, 4, v1
    v_xor_b32 v4, v2, v3
    v_lshlrev_b32 v4, 4, v4
    v_lshl_add_u32 v4, v3, 8, v4
    s_lshl_b32 s64, s3, 12
    v_xor_b32 v216, 0, v4
    v_add_u32 v216, s64, v216
    v_xor_b32 v217, 64, v4
    v_add_u32 v217, s64, v217
    v_xor_b32 v218, 128, v4
    v_add_u32 v218, s64, v218
    v_xor_b32 v219, 192, v4
    v_add_u32 v219, s64, v219
    s_lshl_b32 s64, s3, 2
    v_add_u32 v3, s64, v3
    v_xor_b32 v4, v2, v3
    v_lshlrev_b32 v4, 4, v4
    v_lshl_add_u32 v220, v2, 8, v4
    v_mul_u32_u24 v221, 1280, v3
    v_lshl_add_u32 v221, v2, 3, v221
    v_lshrrev_b32 v2, 4, v1
    v_lshlrev_b32 v2, 3, v2
    s_lshl_b32 s65, s59, 7
    s_cmp_eq_u32 s3, 0
    s_cselect_b32 s65, s65, 1073741824
    buffer_load_ushort v60, v7, s[28:31], s66 offen offset:0
    buffer_load_ushort v64, v7, s[28:31], s66 offen offset:32
    buffer_load_dwordx2 v[240:241], v2, s[32:35], s65 offen offset:0
    buffer_load_dwordx2 v[242:243], v2, s[32:35], s65 offen offset:32
    buffer_load_dwordx2 v[244:245], v2, s[32:35], s65 offen offset:64
    buffer_load_dwordx2 v[246:247], v2, s[32:35], s65 offen offset:96
    s_and_b32 s74, s6, 15
    s_lshr_b64 s[6:7], s[6:7], 4
    s_add_u32 s74, s74, s61
    s_cmp_ge_u32 s74, 10
    s_cselect_b32 s75, 10, 0
    s_sub_u32 s74, s74, s75
    s_lshl_b32 s75, s74, 7
    s_add_u32 s70, s92, s75
    s_mul_i32 s75, s74, 221184
    s_add_u32 s71, s93, s75
    s_add_u32 m0, s68, 16384
    s_nop 0
    buffer_load_dwordx4 v16, s[8:11], s70 offen offset:0  lds
    buffer_load_dwordx4 v17, s[8:11], s70 offen offset:1024  lds
    s_add_u32 m0, s69, 32768
    s_nop 0
    buffer_load_dwordx4 v18, s[12:15], s71 offen offset:0  lds
    buffer_load_dwordx4 v19, s[12:15], s71 offen offset:1024  lds
    buffer_load_dwordx4 v20, s[12:15], s71 offen offset:2048  lds
    buffer_load_dwordx4 v21, s[12:15], s71 offen offset:3072  lds
    s_and_b32 s74, s6, 15
    s_lshr_b64 s[6:7], s[6:7], 4
    s_add_u32 s74, s74, s61
    s_cmp_ge_u32 s74, 10
    s_cselect_b32 s75, 10, 0
    s_sub_u32 s74, s74, s75
    s_lshl_b32 s75, s74, 7
    s_add_u32 s72, s92, s75
    s_mul_i32 s75, s74, 221184
    s_add_u32 s73, s93, s75
    s_mul_i32 s64, s61, 0x01010101
    s_mov_b32 s67, 0x0f0f0f0f
    s_and_b32 s65, s76, s67
    s_add_u32 s65, s65, s64
    s_add_u32 s66, s65, 0x76767676
    s_and_b32 s66, s66, 0x80808080
    s_lshr_b32 s66, s66, 7
    s_mul_i32 s66, s66, 10
    s_sub_u32 s65, s65, s66
    s_mov_b32 s75, s65
    s_lshr_b32 s65, s76, 4
    s_and_b32 s65, s65, s67
    s_add_u32 s65, s65, s64
    s_add_u32 s66, s65, 0x76767676
    s_and_b32 s66, s66, 0x80808080
    s_lshr_b32 s66, s66, 7
    s_mul_i32 s66, s66, 10
    s_sub_u32 s65, s65, s66
    s_lshl_b32 s65, s65, 4
    s_or_b32 s76, s75, s65
    s_and_b32 s65, s77, s67
    s_add_u32 s65, s65, s64
    s_add_u32 s66, s65, 0x76767676
    s_and_b32 s66, s66, 0x80808080
    s_lshr_b32 s66, s66, 7
    s_mul_i32 s66, s66, 10
    s_sub_u32 s65, s65, s66
    s_mov_b32 s75, s65
    s_lshr_b32 s65, s77, 4
    s_and_b32 s65, s65, s67
    s_add_u32 s65, s65, s64
    s_add_u32 s66, s65, 0x76767676
    s_and_b32 s66, s66, 0x80808080
    s_lshr_b32 s66, s66, 7
    s_mul_i32 s66, s66, 10
    s_sub_u32 s65, s65, s66
    s_lshl_b32 s65, s65, 4
    s_or_b32 s77, s75, s65
    s_add_u32 s81, s92, 81920
    s_mov_b64 exec, 0
    s_mov_b32 s63, 1
    s_branch L_pg0_0
L_pg0_3:
L_pgret0:
    s_cmp_eq_u32 s63, 1
    s_cbranch_scc1 L_pgback0
    s_endpgm
L_pgback0:
    s_mov_b32 s63, 0
    s_mov_b64 exec, -1
    s_waitcnt vmcnt(18)
    s_barrier
    ds_read_b64_tr_b16 a[0:1], v26 offset:0
    ds_read_b64_tr_b16 a[2:3], v26 offset:1024
    ds_read_b64_tr_b16 a[4:5], v27 offset:0
    ds_read_b64_tr_b16 a[6:7], v27 offset:1024
    ds_read_b128 v[36:39], v22 offset:0
    ds_read_b128 v[40:43], v22 offset:2048
    ds_read_b128 v[44:47], v22 offset:4096
    ds_read_b128 v[48:51], v22 offset:6144
    s_waitcnt lgkmcnt(2)
    v_mfma_f32_16x16x32_bf16 v[68:71], a[0:3], v[36:39], 0
    ds_read_b64_tr_b16 a[8:9], v26 offset:8192
    ds_read_b64_tr_b16 a[10:11], v26 offset:9216
    v_mfma_f32_16x16x32_bf16 v[72:75], a[4:7], v[36:39], 0
    v_mfma_f32_16x16x32_bf16 v[76:79], a[0:3], v[40:43], 0
    ds_read_b64_tr_b16 a[12:13], v27 offset:8192
    ds_read_b64_tr_b16 a[14:15], v27 offset:9216
    v_mfma_f32_16x16x32_bf16 v[80:83], a[4:7], v[40:43], 0
    ds_read_b128 v[52:55], v23 offset:0
    ds_read_b128 v[56:59], v23 offset:2048
    s_waitcnt lgkmcnt(6)
    v_mfma_f32_16x16x32_bf16 v[84:87], a[0:3], v[44:47], 0
    ds_read_b128 v[36:39], v23 offset:4096
    s_and_b32 s74, s6, 15
    v_mfma_f32_16x16x32_bf16 v[88:91], a[4:7], v[44:47], 0
    s_lshr_b64 s[6:7], s[6:7], 4
    v_mfma_f32_16x16x32_bf16 v[92:95], a[0:3], v[48:51], 0
    ds_read_b128 v[40:43], v23 offset:6144
    s_add_u32 s74, s74, s61
    v_mfma_f32_16x16x32_bf16 v[96:99], a[4:7], v[48:51], 0
    s_cmp_ge_u32 s74, 10
    s_cselect_b32 s75, 10, 0
    s_waitcnt lgkmcnt(2)
    v_mfma_f32_16x16x32_bf16 v[68:71], a[8:11], v[52:55], v[68:71]
    s_waitcnt vmcnt(12)
    s_barrier
    ds_read_b64_tr_b16 a[16:17], v26 offset:16384
    ds_read_b64_tr_b16 a[18:19], v26 offset:17408
    s_sub_u32 s74, s74, s75
    v_mfma_f32_16x16x32_bf16 v[72:75], a[12:15], v[52:55], v[72:75]
    s_add_u32 m0, s68, 24576
    s_nop 0
    buffer_load_dwordx4 v16, s[8:11], s72 offen offset:0  lds
    v_mfma_f32_16x16x32_bf16 v[76:79], a[8:11], v[56:59], v[76:79]
    ds_read_b64_tr_b16 a[20:21], v27 offset:16384
    ds_read_b64_tr_b16 a[22:23], v27 offset:17408
    s_lshl_b32 s75, s74, 7
    v_mfma_f32_16x16x32_bf16 v[80:83], a[12:15], v[56:59], v[80:83]
    ds_read_b128 v[44:47], v22 offset:8192
    ds_read_b128 v[48:51], v22 offset:10240
    buffer_load_dwordx4 v17, s[8:11], s72 offen offset:1024  lds
    s_waitcnt lgkmcnt(6)
    v_mfma_f32_16x16x32_bf16 v[84:87], a[8:11], v[36:39], v[84:87]
    ds_read_b128 v[52:55], v22 offset:12288
    s_add_u32 s70, s92, s75
    v_mfma_f32_16x16x32_bf16 v[88:91], a[12:15], v[36:39], v[88:91]
    s_add_u32 m0, s69, 49152
    s_nop 0
    buffer_load_dwordx4 v18, s[12:15], s73 offen offset:0  lds
    s_mul_i32 s75, s74, 221184
    v_mfma_f32_16x16x32_bf16 v[92:95], a[8:11], v[40:43], v[92:95]
    ds_read_b128 v[56:59], v22 offset:14336
    s_add_u32 s71, s93, s75
    v_mfma_f32_16x16x32_bf16 v[96:99], a[12:15], v[40:43], v[96:99]
    buffer_load_dwordx4 v19, s[12:15], s73 offen offset:1024  lds
    s_waitcnt lgkmcnt(2)
    v_mfma_f32_16x16x32_bf16 v[68:71], a[16:19], v[44:47], v[68:71]
    ds_read_b64_tr_b16 a[24:25], v26 offset:24576
    ds_read_b64_tr_b16 a[26:27], v26 offset:25600
    buffer_load_dword v15, off, s[36:39], 0 sc1
    v_mfma_f32_16x16x32_bf16 v[72:75], a[20:23], v[44:47], v[72:75]
    buffer_load_dwordx4 v20, s[12:15], s73 offen offset:2048  lds
    v_mfma_f32_16x16x32_bf16 v[76:79], a[16:19], v[48:51], v[76:79]
    ds_read_b64_tr_b16 a[28:29], v27 offset:24576
    ds_read_b64_tr_b16 a[30:31], v27 offset:25600
    v_mfma_f32_16x16x32_bf16 v[80:83], a[20:23], v[48:51], v[80:83]
    ds_read_b128 v[36:39], v23 offset:8192
    ds_read_b128 v[40:43], v23 offset:10240
    buffer_load_dwordx4 v21, s[12:15], s73 offen offset:3072  lds
    s_waitcnt lgkmcnt(6)
    v_mfma_f32_16x16x32_bf16 v[84:87], a[16:19], v[52:55], v[84:87]
    ds_read_b128 v[44:47], v23 offset:12288
    s_and_b32 s74, s6, 15
    v_mfma_f32_16x16x32_bf16 v[88:91], a[20:23], v[52:55], v[88:91]
    s_lshr_b64 s[6:7], s[6:7], 4
    v_mfma_f32_16x16x32_bf16 v[92:95], a[16:19], v[56:59], v[92:95]
    ds_read_b128 v[48:51], v23 offset:14336
    s_add_u32 s74, s74, s61
    v_mfma_f32_16x16x32_bf16 v[96:99], a[20:23], v[56:59], v[96:99]
    s_cmp_ge_u32 s74, 10
    s_cselect_b32 s75, 10, 0
    s_waitcnt lgkmcnt(2)
    v_mfma_f32_16x16x32_bf16 v[68:71], a[24:27], v[36:39], v[68:71]
    s_waitcnt vmcnt(7)
    s_barrier
    ds_read_b64_tr_b16 a[32:33], v26 offset:32768
    ds_read_b64_tr_b16 a[34:35], v26 offset:33792
    s_sub_u32 s74, s74, s75
    v_mfma_f32_16x16x32_bf16 v[72:75], a[28:31], v[36:39], v[72:75]
    s_add_u32 m0, s68, 0
    s_nop 0
    buffer_load_dwordx4 v16, s[8:11], s70 offen offset:0  lds
    v_mfma_f32_16x16x32_bf16 v[76:79], a[24:27], v[40:43], v[76:79]
    ds_read_b64_tr_b16 a[36:37], v27 offset:32768
    ds_read_b64_tr_b16 a[38:39], v27 offset:33792
    s_lshl_b32 s75, s74, 7
    v_mfma_f32_16x16x32_bf16 v[80:83], a[28:31], v[40:43], v[80:83]
    ds_read_b128 v[52:55], v22 offset:16384
    ds_read_b128 v[56:59], v22 offset:18432
    buffer_load_dwordx4 v17, s[8:11], s70 offen offset:1024  lds
    s_waitcnt lgkmcnt(6)
    v_mfma_f32_16x16x32_bf16 v[84:87], a[24:27], v[44:47], v[84:87]
    ds_read_b128 v[36:39], v22 offset:20480
    s_add_u32 s72, s92, s75
    v_mfma_f32_16x16x32_bf16 v[88:91], a[28:31], v[44:47], v[88:91]
    s_add_u32 m0, s69, 0
    s_nop 0
    buffer_load_dwordx4 v18, s[12:15], s71 offen offset:0  lds
    s_mul_i32 s75, s74, 221184
    v_mfma_f32_16x16x32_bf16 v[92:95], a[24:27], v[48:51], v[92:95]
    ds_read_b128 v[40:43], v22 offset:22528
    s_add_u32 s73, s93, s75
    v_mfma_f32_16x16x32_bf16 v[96:99], a[28:31], v[48:51], v[96:99]
    buffer_load_dwordx4 v19, s[12:15], s71 offen offset:1024  lds
    v_mfma_f32_16x16x32_bf16 v[68:71], v[60:63], v[32:35], v[68:71]
    v_mfma_f32_16x16x32_bf16 v[72:75], v[64:67], v[32:35], v[72:75]
    v_mfma_f32_16x16x32_bf16 v[76:79], v[60:63], v[32:35], v[76:79]
    v_mfma_f32_16x16x32_bf16 v[80:83], v[64:67], v[32:35], v[80:83]
    v_mfma_f32_16x16x32_bf16 v[84:87], v[60:63], v[32:35], v[84:87]
    v_mfma_f32_16x16x32_bf16 v[88:91], v[64:67], v[32:35], v[88:91]
    v_mfma_f32_16x16x32_bf16 v[92:95], v[60:63], v[32:35], v[92:95]
    v_mfma_f32_16x16x32_bf16 v[96:99], v[64:67], v[32:35], v[96:99]
    v_mfma_f32_16x16x32_bf16 v[100:103], v[60:63], v[32:35], 0
    v_mfma_f32_16x16x32_bf16 v[104:107], v[64:67], v[32:35], 0
    v_mfma_f32_16x16x32_bf16 v[108:111], v[60:63], v[32:35], 0
    v_mfma_f32_16x16x32_bf16 v[112:115], v[64:67], v[32:35], 0
    v_mfma_f32_16x16x32_bf16 v[116:119], v[60:63], v[32:35], 0
    v_mfma_f32_16x16x32_bf16 v[120:123], v[64:67], v[32:35], 0
    v_mfma_f32_16x16x32_bf16 v[124:127], v[60:63], v[32:35], 0
    v_mfma_f32_16x16x32_bf16 v[128:131], v[64:67], v[32:35], 0
    s_waitcnt lgkmcnt(2)
    v_mfma_f32_16x16x32_bf16 v[68:71], a[32:35], v[52:55], v[68:71]
    ds_read_b64_tr_b16 a[40:41], v26 offset:40960
    ds_read_b64_tr_b16 a[42:43], v26 offset:41984
    v_mfma_f32_16x16x32_bf16 v[72:75], a[36:39], v[52:55], v[72:75]
    buffer_load_dwordx4 v20, s[12:15], s71 offen offset:2048  lds
    v_mfma_f32_16x16x32_bf16 v[76:79], a[32:35], v[56:59], v[76:79]
    ds_read_b64_tr_b16 a[44:45], v27 offset:40960
    ds_read_b64_tr_b16 a[46:47], v27 offset:41984
    v_mfma_f32_16x16x32_bf16 v[80:83], a[36:39], v[56:59], v[80:83]
    ds_read_b128 v[44:47], v23 offset:16384
    ds_read_b128 v[48:51], v23 offset:18432
    buffer_load_dwordx4 v21, s[12:15], s71 offen offset:3072  lds
    s_waitcnt lgkmcnt(6)
    v_mfma_f32_16x16x32_bf16 v[84:87], a[32:35], v[36:39], v[84:87]
    ds_read_b128 v[52:55], v23 offset:20480
    s_and_b32 s74, s6, 15
    v_mfma_f32_16x16x32_bf16 v[88:91], a[36:39], v[36:39], v[88:91]
    s_lshr_b64 s[6:7], s[6:7], 4
    v_mfma_f32_16x16x32_bf16 v[92:95], a[32:35], v[40:43], v[92:95]
    ds_read_b128 v[56:59], v23 offset:22528
    s_add_u32 s74, s74, s61
    v_mfma_f32_16x16x32_bf16 v[96:99], a[36:39], v[40:43], v[96:99]
    s_cmp_ge_u32 s74, 10
    s_cselect_b32 s75, 10, 0
    s_waitcnt lgkmcnt(2)
    v_mfma_f32_16x16x32_bf16 v[68:71], a[40:43], v[44:47], v[68:71]
    s_waitcnt vmcnt(6)
    s_barrier
    ds_read_b64_tr_b16 a[48:49], v26 offset:49152
    ds_read_b64_tr_b16 a[50:51], v26 offset:50176
    s_sub_u32 s74, s74, s75
    v_mfma_f32_16x16x32_bf16 v[72:75], a[44:47], v[44:47], v[72:75]
    s_add_u32 m0, s68, 8192
    s_nop 0
    buffer_load_dwordx4 v16, s[8:11], s72 offen offset:0  lds
    v_mfma_f32_16x16x32_bf16 v[76:79], a[40:43], v[48:51], v[76:79]
    ds_read_b64_tr_b16 a[52:53], v27 offset:49152
    ds_read_b64_tr_b16 a[54:55], v27 offset:50176
    s_lshl_b32 s75, s74, 7
    v_mfma_f32_16x16x32_bf16 v[80:83], a[44:47], v[48:51], v[80:83]
    ds_read_b128 v[36:39], v22 offset:24576
    ds_read_b128 v[40:43], v22 offset:26624
    buffer_load_dwordx4 v17, s[8:11], s72 offen offset:1024  lds
    s_waitcnt lgkmcnt(6)
    v_mfma_f32_16x16x32_bf16 v[84:87], a[40:43], v[52:55], v[84:87]
L_pg0_0:
    s_cbranch_execz L_pg0_1
    s_nop 0
    ds_read_b128 v[44:47], v22 offset:28672
    s_add_u32 s70, s92, s75
    v_mfma_f32_16x16x32_bf16 v[88:91], a[44:47], v[52:55], v[88:91]
    s_add_u32 m0, s69, 16384
    s_nop 0
    buffer_load_dwordx4 v18, s[12:15], s73 offen offset:0  lds
    s_mul_i32 s75, s74, 221184
    v_mfma_f32_16x16x32_bf16 v[92:95], a[40:43], v[56:59], v[92:95]
    ds_read_b128 v[48:51], v22 offset:30720
    s_add_u32 s71, s93, s75
    v_mfma_f32_16x16x32_bf16 v[96:99], a[44:47], v[56:59], v[96:99]
    buffer_load_dwordx4 v19, s[12:15], s73 offen offset:1024  lds
    s_waitcnt lgkmcnt(2)
    v_mfma_f32_16x16x32_bf16 v[68:71], a[48:51], v[36:39], v[68:71]
    ds_read_b64_tr_b16 a[56:57], v26 offset:57344
    ds_read_b64_tr_b16 a[58:59], v26 offset:58368
    v_lshlrev_b32 v224, 16, v240
    v_mfma_f32_16x16x32_bf16 v[72:75], a[52:55], v[36:39], v[72:75]
    buffer_load_dwordx4 v20, s[12:15], s73 offen offset:2048  lds
    v_mfma_f32_16x16x32_bf16 v[76:79], a[48:51], v[40:43], v[76:79]
    ds_read_b64_tr_b16 a[60:61], v27 offset:57344
    ds_read_b64_tr_b16 a[62:63], v27 offset:58368
    v_and_b32 v225, 0xffff0000, v240
    v_mfma_f32_16x16x32_bf16 v[80:83], a[52:55], v[40:43], v[80:83]
    ds_read_b128 v[52:55], v23 offset:24576
    ds_read_b128 v[56:59], v23 offset:26624
    buffer_load_dwordx4 v21, s[12:15], s73 offen offset:3072  lds
    s_waitcnt lgkmcnt(6)
    v_mfma_f32_16x16x32_bf16 v[84:87], a[48:51], v[44:47], v[84:87]
    ds_read_b128 v[36:39], v23 offset:28672
    s_and_b32 s74, s6, 15
    v_mfma_f32_16x16x32_bf16 v[88:91], a[52:55], v[44:47], v[88:91]
    s_lshr_b64 s[6:7], s[6:7], 4
    v_mfma_f32_16x16x32_bf16 v[92:95], a[48:51], v[48:51], v[92:95]
    ds_read_b128 v[40:43], v23 offset:30720
    s_add_u32 s74, s74, s61
    v_mfma_f32_16x16x32_bf16 v[96:99], a[52:55], v[48:51], v[96:99]
    s_cmp_ge_u32 s74, 10
    s_cselect_b32 s75, 10, 0
    s_waitcnt lgkmcnt(2)
    v_mfma_f32_16x16x32_bf16 v[68:71], a[56:59], v[52:55], v[68:71]
    s_waitcnt vmcnt(6)
    s_barrier
    ds_read_b64_tr_b16 a[64:65], v26 offset:0
    ds_read_b64_tr_b16 a[66:67], v26 offset:1024
    s_sub_u32 s74, s74, s75
    v_mfma_f32_16x16x32_bf16 v[72:75], a[60:63], v[52:55], v[72:75]
    s_add_u32 m0, s68, 16384
    s_nop 0
    buffer_load_dwordx4 v16, s[8:11], s70 offen offset:0  lds
    v_mfma_f32_16x16x32_bf16 v[76:79], a[56:59], v[56:59], v[76:79]
    ds_read_b64_tr_b16 a[68:69], v27 offset:0
    ds_read_b64_tr_b16 a[70:71], v27 offset:1024
    s_lshl_b32 s75, s74, 7
    v_mfma_f32_16x16x32_bf16 v[80:83], a[60:63], v[56:59], v[80:83]
    ds_read_b128 v[44:47], v22 offset:0
    ds_read_b128 v[48:51], v22 offset:2048
    buffer_load_dwordx4 v17, s[8:11], s70 offen offset:1024  lds
    s_waitcnt lgkmcnt(6)
    v_mfma_f32_16x16x32_bf16 v[84:87], a[56:59], v[36:39], v[84:87]
    ds_read_b128 v[52:55], v22 offset:4096
    s_add_u32 s72, s92, s75
    v_mfma_f32_16x16x32_bf16 v[88:91], a[60:63], v[36:39], v[88:91]
    s_add_u32 m0, s69, 32768
    s_nop 0
    buffer_load_dwordx4 v18, s[12:15], s71 offen offset:0  lds
    s_mul_i32 s75, s74, 221184
    v_mfma_f32_16x16x32_bf16 v[92:95], a[56:59], v[40:43], v[92:95]
    ds_read_b128 v[56:59], v22 offset:6144
    s_add_u32 s73, s93, s75
    v_mfma_f32_16x16x32_bf16 v[96:99], a[60:63], v[40:43], v[96:99]
    buffer_load_dwordx4 v19, s[12:15], s71 offen offset:1024  lds
    v_lshlrev_b32 v226, 16, v241
    s_waitcnt lgkmcnt(2)
    v_mfma_f32_16x16x32_bf16 v[68:71], a[64:67], v[44:47], v[68:71]
    ds_read_b64_tr_b16 a[72:73], v26 offset:8192
    ds_read_b64_tr_b16 a[74:75], v26 offset:9216
    v_and_b32 v227, 0xffff0000, v241
    v_mfma_f32_16x16x32_bf16 v[72:75], a[68:71], v[44:47], v[72:75]
    buffer_load_dwordx4 v20, s[12:15], s71 offen offset:2048  lds
    v_mfma_f32_16x16x32_bf16 v[76:79], a[64:67], v[48:51], v[76:79]
    ds_read_b64_tr_b16 a[76:77], v27 offset:8192
    ds_read_b64_tr_b16 a[78:79], v27 offset:9216
    v_lshlrev_b32 v228, 16, v242
    v_mfma_f32_16x16x32_bf16 v[80:83], a[68:71], v[48:51], v[80:83]
    ds_read_b128 v[36:39], v23 offset:0
    ds_read_b128 v[40:43], v23 offset:2048
    buffer_load_dwordx4 v21, s[12:15], s71 offen offset:3072  lds
    s_waitcnt lgkmcnt(6)
    v_mfma_f32_16x16x32_bf16 v[84:87], a[64:67], v[52:55], v[84:87]
    ds_read_b128 v[44:47], v23 offset:4096
    s_and_b32 s74, s6, 15
    v_mfma_f32_16x16x32_bf16 v[88:91], a[68:71], v[52:55], v[88:91]
    s_lshr_b64 s[6:7], s[6:7], 4
    v_mfma_f32_16x16x32_bf16 v[92:95], a[64:67], v[56:59], v[92:95]
    ds_read_b128 v[48:51], v23 offset:6144
    s_add_u32 s74, s74, s61
    v_mfma_f32_16x16x32_bf16 v[96:99], a[68:71], v[56:59], v[96:99]
    s_cmp_ge_u32 s74, 10
    s_cselect_b32 s75, 10, 0
    s_waitcnt lgkmcnt(2)
    v_mfma_f32_16x16x32_bf16 v[68:71], a[72:75], v[36:39], v[68:71]
    s_waitcnt vmcnt(6)
    s_barrier
    ds_read_b64_tr_b16 a[80:81], v26 offset:16384
    ds_read_b64_tr_b16 a[82:83], v26 offset:17408
    s_sub_u32 s74, s74, s75
    v_mfma_f32_16x16x32_bf16 v[72:75], a[76:79], v[36:39], v[72:75]
    s_add_u32 m0, s68, 24576
    s_nop 0
    buffer_load_dwordx4 v16, s[8:11], s72 offen offset:0  lds
    v_mfma_f32_16x16x32_bf16 v[76:79], a[72:75], v[40:43], v[76:79]
    ds_read_b64_tr_b16 a[84:85], v27 offset:16384
    ds_read_b64_tr_b16 a[86:87], v27 offset:17408
    s_lshl_b32 s75, s74, 7
    v_mfma_f32_16x16x32_bf16 v[80:83], a[76:79], v[40:43], v[80:83]
    ds_read_b128 v[52:55], v22 offset:8192
    ds_read_b128 v[56:59], v22 offset:10240
    buffer_load_dwordx4 v17, s[8:11], s72 offen offset:1024  lds
    s_waitcnt lgkmcnt(6)
    v_mfma_f32_16x16x32_bf16 v[84:87], a[72:75], v[44:47], v[84:87]
    ds_read_b128 v[36:39], v22 offset:12288
    s_add_u32 s70, s92, s75
    v_mfma_f32_16x16x32_bf16 v[88:91], a[76:79], v[44:47], v[88:91]
    s_add_u32 m0, s69, 49152
    s_nop 0
    buffer_load_dwordx4 v18, s[12:15], s73 offen offset:0  lds
    s_mul_i32 s75, s74, 221184
    v_mfma_f32_16x16x32_bf16 v[92:95], a[72:75], v[48:51], v[92:95]
    ds_read_b128 v[40:43], v22 offset:14336
    s_add_u32 s71, s93, s75
    v_mfma_f32_16x16x32_bf16 v[96:99], a[76:79], v[48:51], v[96:99]
    buffer_load_dwordx4 v19, s[12:15], s73 offen offset:1024  lds
    v_and_b32 v229, 0xffff0000, v242
    s_waitcnt lgkmcnt(2)
    v_mfma_f32_16x16x32_bf16 v[68:71], a[80:83], v[52:55], v[68:71]
    ds_read_b64_tr_b16 a[88:89], v26 offset:24576
    ds_read_b64_tr_b16 a[90:91], v26 offset:25600
    v_lshlrev_b32 v230, 16, v243
    v_mfma_f32_16x16x32_bf16 v[72:75], a[84:87], v[52:55], v[72:75]
    buffer_load_dwordx4 v20, s[12:15], s73 offen offset:2048  lds
    v_mfma_f32_16x16x32_bf16 v[76:79], a[80:83], v[56:59], v[76:79]
    ds_read_b64_tr_b16 a[92:93], v27 offset:24576
    ds_read_b64_tr_b16 a[94:95], v27 offset:25600
    v_and_b32 v231, 0xffff0000, v243
    v_mfma_f32_16x16x32_bf16 v[80:83], a[84:87], v[56:59], v[80:83]
    ds_read_b128 v[44:47], v23 offset:8192
    ds_read_b128 v[48:51], v23 offset:10240
    buffer_load_dwordx4 v21, s[12:15], s73 offen offset:3072  lds
    s_waitcnt lgkmcnt(6)
    v_mfma_f32_16x16x32_bf16 v[84:87], a[80:83], v[36:39], v[84:87]
    ds_read_b128 v[52:55], v23 offset:12288
    s_and_b32 s74, s6, 15
    v_mfma_f32_16x16x32_bf16 v[88:91], a[84:87], v[36:39], v[88:91]
    s_lshr_b64 s[6:7], s[6:7], 4
    v_mfma_f32_16x16x32_bf16 v[92:95], a[80:83], v[40:43], v[92:95]
    ds_read_b128 v[56:59], v23 offset:14336
    s_add_u32 s74, s74, s61
    v_mfma_f32_16x16x32_bf16 v[96:99], a[84:87], v[40:43], v[96:99]
    s_cmp_ge_u32 s74, 10
    s_cselect_b32 s75, 10, 0
    s_waitcnt lgkmcnt(2)
    v_mfma_f32_16x16x32_bf16 v[68:71], a[88:91], v[44:47], v[68:71]
    s_waitcnt vmcnt(6)
    s_barrier
    ds_read_b64_tr_b16 a[96:97], v26 offset:32768
    ds_read_b64_tr_b16 a[98:99], v26 offset:33792
    s_sub_u32 s74, s74, s75
    v_mfma_f32_16x16x32_bf16 v[72:75], a[92:95], v[44:47], v[72:75]
    s_add_u32 m0, s68, 0
    s_nop 0
    buffer_load_dwordx4 v16, s[8:11], s70 offen offset:0  lds
    v_mfma_f32_16x16x32_bf16 v[76:79], a[88:91], v[48:51], v[76:79]
    ds_read_b64_tr_b16 a[100:101], v27 offset:32768
    ds_read_b64_tr_b16 a[102:103], v27 offset:33792
    s_lshl_b32 s75, s74, 7
    v_mfma_f32_16x16x32_bf16 v[80:83], a[92:95], v[48:51], v[80:83]
    ds_read_b128 v[36:39], v22 offset:16384
    ds_read_b128 v[40:43], v22 offset:18432
    buffer_load_dwordx4 v17, s[8:11], s70 offen offset:1024  lds
    s_waitcnt lgkmcnt(6)
    v_mfma_f32_16x16x32_bf16 v[84:87], a[88:91], v[52:55], v[84:87]
    ds_read_b128 v[44:47], v22 offset:20480
    s_add_u32 s72, s92, s75
    v_mfma_f32_16x16x32_bf16 v[88:91], a[92:95], v[52:55], v[88:91]
    s_add_u32 m0, s69, 0
    s_nop 0
    buffer_load_dwordx4 v18, s[12:15], s71 offen offset:0  lds
    s_mul_i32 s75, s74, 221184
    v_mfma_f32_16x16x32_bf16 v[92:95], a[88:91], v[56:59], v[92:95]
    ds_read_b128 v[48:51], v22 offset:22528
    s_add_u32 s73, s93, s75
    v_mfma_f32_16x16x32_bf16 v[96:99], a[92:95], v[56:59], v[96:99]
    buffer_load_dwordx4 v19, s[12:15], s71 offen offset:1024  lds
    v_lshlrev_b32 v232, 16, v244
    s_waitcnt lgkmcnt(2)
    v_mfma_f32_16x16x32_bf16 v[68:71], a[96:99], v[36:39], v[68:71]
    ds_read_b64_tr_b16 a[104:105], v26 offset:40960
    ds_read_b64_tr_b16 a[106:107], v26 offset:41984
    v_and_b32 v233, 0xffff0000, v244
    v_mfma_f32_16x16x32_bf16 v[72:75], a[100:103], v[36:39], v[72:75]
    buffer_load_dwordx4 v20, s[12:15], s71 offen offset:2048  lds
    v_mfma_f32_16x16x32_bf16 v[76:79], a[96:99], v[40:43], v[76:79]
    ds_read_b64_tr_b16 a[108:109], v27 offset:40960
    ds_read_b64_tr_b16 a[110:111], v27 offset:41984
    v_lshlrev_b32 v234, 16, v245
    v_mfma_f32_16x16x32_bf16 v[80:83], a[100:103], v[40:43], v[80:83]
    ds_read_b128 v[52:55], v23 offset:16384
    ds_read_b128 v[56:59], v23 offset:18432
    buffer_load_dwordx4 v21, s[12:15], s71 offen offset:3072  lds
    s_waitcnt lgkmcnt(6)
    v_mfma_f32_16x16x32_bf16 v[84:87], a[96:99], v[44:47], v[84:87]
    ds_read_b128 v[36:39], v23 offset:20480
    v_and_b32 v235, 0xffff0000, v245
    v_mfma_f32_16x16x32_bf16 v[88:91], a[100:103], v[44:47], v[88:91]
    v_lshlrev_b32 v236, 16, v246
    v_mfma_f32_16x16x32_bf16 v[92:95], a[96:99], v[48:51], v[92:95]
    ds_read_b128 v[40:43], v23 offset:22528
    v_and_b32 v237, 0xffff0000, v246
    v_mfma_f32_16x16x32_bf16 v[96:99], a[100:103], v[48:51], v[96:99]
    v_lshlrev_b32 v238, 16, v247
    s_waitcnt lgkmcnt(2)
    v_mfma_f32_16x16x32_bf16 v[68:71], a[104:107], v[52:55], v[68:71]
    s_waitcnt vmcnt(6)
    s_barrier
    ds_read_b64_tr_b16 a[112:113], v26 offset:49152
    ds_read_b64_tr_b16 a[114:115], v26 offset:50176
    v_and_b32 v239, 0xffff0000, v247
    v_mfma_f32_16x16x32_bf16 v[72:75], a[108:111], v[52:55], v[72:75]
    s_add_u32 m0, s68, 8192
    s_nop 0
    buffer_load_dwordx4 v16, s[8:11], s72 offen offset:0  lds
    v_mfma_f32_16x16x32_bf16 v[76:79], a[104:107], v[56:59], v[76:79]
    ds_read_b64_tr_b16 a[116:117], v27 offset:49152
    ds_read_b64_tr_b16 a[118:119], v27 offset:50176
    s_mul_i32 s66, s3, 14336
    v_mfma_f32_16x16x32_bf16 v[80:83], a[108:111], v[56:59], v[80:83]
    ds_read_b128 v[44:47], v22 offset:24576
    ds_read_b128 v[48:51], v22 offset:26624
    buffer_load_dwordx4 v17, s[8:11], s72 offen offset:1024  lds
    s_waitcnt lgkmcnt(6)
    v_mfma_f32_16x16x32_bf16 v[84:87], a[104:107], v[36:39], v[84:87]
    ds_read_b128 v[52:55], v22 offset:28672
    s_add_u32 s66, s66, 1048576
    v_mfma_f32_16x16x32_bf16 v[88:91], a[108:111], v[36:39], v[88:91]
    s_add_u32 m0, s69, 16384
    s_nop 0
    buffer_load_dwordx4 v18, s[12:15], s73 offen offset:0  lds
    s_lshl_b32 s67, s59, 7
    v_mfma_f32_16x16x32_bf16 v[92:95], a[104:107], v[40:43], v[92:95]
    ds_read_b128 v[56:59], v22 offset:30720
    s_mul_i32 s64, s58, 3
    v_mfma_f32_16x16x32_bf16 v[96:99], a[108:111], v[40:43], v[96:99]
    buffer_load_dwordx4 v19, s[12:15], s73 offen offset:1024  lds
    s_add_u32 s64, s64, 0
    s_waitcnt lgkmcnt(2)
    v_mfma_f32_16x16x32_bf16 v[68:71], a[112:115], v[44:47], v[68:71]
    ds_read_b64_tr_b16 a[120:121], v26 offset:57344
    ds_read_b64_tr_b16 a[122:123], v26 offset:58368
    s_and_b32 s65, s64, 60
    v_mfma_f32_16x16x32_bf16 v[72:75], a[116:119], v[44:47], v[72:75]
    buffer_load_dwordx4 v20, s[12:15], s73 offen offset:2048  lds
    v_mfma_f32_16x16x32_bf16 v[76:79], a[112:115], v[48:51], v[76:79]
    ds_read_b64_tr_b16 a[124:125], v27 offset:57344
    ds_read_b64_tr_b16 a[126:127], v27 offset:58368
    s_cmp_lt_u32 s64, 64
    s_cselect_b32 s64, s64, 0x1000
    v_mfma_f32_16x16x32_bf16 v[80:83], a[116:119], v[48:51], v[80:83]
    ds_read_b128 v[36:39], v23 offset:24576
    ds_read_b128 v[40:43], v23 offset:26624
    buffer_load_dwordx4 v21, s[12:15], s73 offen offset:3072  lds
    s_waitcnt lgkmcnt(6)
    v_mfma_f32_16x16x32_bf16 v[84:87], a[112:115], v[52:55], v[84:87]
    ds_read_b128 v[44:47], v23 offset:28672
    s_add_u32 s64, s64, s65
    v_mfma_f32_16x16x32_bf16 v[88:91], a[116:119], v[52:55], v[88:91]
    s_mul_i32 s65, s64, 55424
    v_mfma_f32_16x16x32_bf16 v[92:95], a[112:115], v[56:59], v[92:95]
    ds_read_b128 v[48:51], v23 offset:30720
    s_add_u32 s28, s65, s66
    v_mfma_f32_16x16x32_bf16 v[96:99], a[116:119], v[56:59], v[96:99]
    s_add_u32 s31, s28, 221696
    s_waitcnt lgkmcnt(2)
    v_mfma_f32_16x16x32_bf16 v[68:71], a[120:123], v[36:39], v[68:71]
    s_waitcnt vmcnt(6)
    s_barrier
    ds_read_b64_tr_b16 a[128:129], v26 offset:0
    ds_read_b64_tr_b16 a[130:131], v26 offset:1024
    s_mul_i32 s65, s64, 20480
    v_mfma_f32_16x16x32_bf16 v[72:75], a[124:127], v[36:39], v[72:75]
    s_bfe_u64 s[0:1], s[76:77], 0x40000
    s_add_u32 m0, s68, 98304
    s_lshl_b32 s0, s0, 7
    s_add_u32 s0, s0, s81
    buffer_load_dwordx4 v16, s[8:11], s0 offen offset:0  lds
    v_mfma_f32_16x16x32_bf16 v[76:79], a[120:123], v[40:43], v[76:79]
    ds_read_b64_tr_b16 a[132:133], v27 offset:0
    ds_read_b64_tr_b16 a[134:135], v27 offset:1024
    s_add_u32 s34, s65, s67
    v_mfma_f32_16x16x32_bf16 v[80:83], a[124:127], v[40:43], v[80:83]
    ds_read_b128 v[52:55], v22 offset:0
    ds_read_b128 v[56:59], v22 offset:2048
    buffer_load_dwordx4 v17, s[8:11], s0 offen offset:1024  lds
    s_waitcnt lgkmcnt(6)
    v_mfma_f32_16x16x32_bf16 v[84:87], a[120:123], v[44:47], v[84:87]
    ds_read_b128 v[36:39], v22 offset:4096
    s_add_u32 s95, s34, 81920
    v_mfma_f32_16x16x32_bf16 v[88:91], a[124:127], v[44:47], v[88:91]
    s_bfe_u64 s[0:1], s[76:77], 0x40004
    s_add_u32 m0, s68, 106496
    s_lshl_b32 s0, s0, 7
    s_add_u32 s0, s0, s81
    buffer_load_dwordx4 v16, s[8:11], s0 offen offset:0  lds
    s_mul_i32 s64, s58, 3
    v_mfma_f32_16x16x32_bf16 v[92:95], a[120:123], v[48:51], v[92:95]
    ds_read_b128 v[40:43], v22 offset:6144
    s_add_u32 s64, s64, 1
    v_mfma_f32_16x16x32_bf16 v[96:99], a[124:127], v[48:51], v[96:99]
    buffer_load_dwordx4 v17, s[8:11], s0 offen offset:1024  lds
    s_and_b32 s65, s64, 60
    s_waitcnt lgkmcnt(2)
    v_mfma_f32_16x16x32_bf16 v[68:71], a[128:131], v[52:55], v[68:71]
    ds_read_b64_tr_b16 a[136:137], v26 offset:8192
    ds_read_b64_tr_b16 a[138:139], v26 offset:9216
    s_cmp_lt_u32 s64, 64
    s_cselect_b32 s64, s64, 0x1000
    v_mfma_f32_16x16x32_bf16 v[72:75], a[132:135], v[52:55], v[72:75]
    s_bfe_u64 s[0:1], s[76:77], 0x40008
    s_add_u32 m0, s68, 114688
    s_lshl_b32 s0, s0, 7
    s_add_u32 s0, s0, s81
    buffer_load_dwordx4 v16, s[8:11], s0 offen offset:0  lds
    v_mfma_f32_16x16x32_bf16 v[76:79], a[128:131], v[56:59], v[76:79]
    ds_read_b64_tr_b16 a[140:141], v27 offset:8192
    ds_read_b64_tr_b16 a[142:143], v27 offset:9216
    s_add_u32 s64, s64, s65
    v_mfma_f32_16x16x32_bf16 v[80:83], a[132:135], v[56:59], v[80:83]
    ds_read_b128 v[44:47], v23 offset:0
    ds_read_b128 v[48:51], v23 offset:2048
    buffer_load_dwordx4 v17, s[8:11], s0 offen offset:1024  lds
    s_waitcnt lgkmcnt(6)
    v_mfma_f32_16x16x32_bf16 v[84:87], a[128:131], v[36:39], v[84:87]
    ds_read_b128 v[52:55], v23 offset:4096
    s_mul_i32 s65, s64, 55424
    v_mfma_f32_16x16x32_bf16 v[88:91], a[132:135], v[36:39], v[88:91]
    s_bfe_u64 s[0:1], s[76:77], 0x4000c
    s_add_u32 m0, s68, 122880
    s_lshl_b32 s0, s0, 7
    s_add_u32 s0, s0, s81
    buffer_load_dwordx4 v16, s[8:11], s0 offen offset:0  lds
    s_add_u32 s29, s65, s66
    v_mfma_f32_16x16x32_bf16 v[92:95], a[128:131], v[40:43], v[92:95]
    ds_read_b128 v[56:59], v23 offset:6144
    s_add_u32 s32, s29, 221696
    v_mfma_f32_16x16x32_bf16 v[96:99], a[132:135], v[40:43], v[96:99]
    buffer_load_dwordx4 v17, s[8:11], s0 offen offset:1024  lds
    s_mul_i32 s65, s64, 20480
    s_waitcnt lgkmcnt(2)
    v_mfma_f32_16x16x32_bf16 v[68:71], a[136:139], v[44:47], v[68:71]
    s_waitcnt vmcnt(8)
    s_barrier
    ds_read_b64_tr_b16 a[144:145], v26 offset:16384
    ds_read_b64_tr_b16 a[146:147], v26 offset:17408
    s_add_u32 s35, s65, s67
    v_mfma_f32_16x16x32_bf16 v[72:75], a[140:143], v[44:47], v[72:75]
    s_bfe_u64 s[0:1], s[76:77], 0x40010
    s_add_u32 m0, s68, 131072
    s_lshl_b32 s0, s0, 7
    s_add_u32 s0, s0, s81
    buffer_load_dwordx4 v16, s[8:11], s0 offen offset:0  lds
    v_mfma_f32_16x16x32_bf16 v[76:79], a[136:139], v[48:51], v[76:79]
    ds_read_b64_tr_b16 a[148:149], v27 offset:16384
    ds_read_b64_tr_b16 a[150:151], v27 offset:17408
    s_add_u32 s96, s35, 81920
    v_mfma_f32_16x16x32_bf16 v[80:83], a[140:143], v[48:51], v[80:83]
    ds_read_b128 v[36:39], v22 offset:8192
    ds_read_b128 v[40:43], v22 offset:10240
    buffer_load_dwordx4 v17, s[8:11], s0 offen offset:1024  lds
    s_waitcnt lgkmcnt(6)
    v_mfma_f32_16x16x32_bf16 v[84:87], a[136:139], v[52:55], v[84:87]
    ds_read_b128 v[44:47], v22 offset:12288
    s_mul_i32 s64, s58, 3
    v_mfma_f32_16x16x32_bf16 v[88:91], a[140:143], v[52:55], v[88:91]
    s_bfe_u64 s[0:1], s[76:77], 0x40014
    s_add_u32 m0, s68, 139264
    s_lshl_b32 s0, s0, 7
    s_add_u32 s0, s0, s81
    buffer_load_dwordx4 v16, s[8:11], s0 offen offset:0  lds
    s_add_u32 s64, s64, 2
    v_mfma_f32_16x16x32_bf16 v[92:95], a[136:139], v[56:59], v[92:95]
    ds_read_b128 v[48:51], v22 offset:14336
    s_and_b32 s65, s64, 60
    v_mfma_f32_16x16x32_bf16 v[96:99], a[140:143], v[56:59], v[96:99]
    buffer_load_dwordx4 v17, s[8:11], s0 offen offset:1024  lds
    s_cmp_lt_u32 s64, 64
    s_cselect_b32 s64, s64, 0x1000
    s_waitcnt lgkmcnt(2)
    v_mfma_f32_16x16x32_bf16 v[68:71], a[144:147], v[36:39], v[68:71]
    ds_read_b64_tr_b16 a[152:153], v26 offset:24576
    ds_read_b64_tr_b16 a[154:155], v26 offset:25600
    s_add_u32 s64, s64, s65
    v_mfma_f32_16x16x32_bf16 v[72:75], a[148:151], v[36:39], v[72:75]
    s_bfe_u64 s[0:1], s[76:77], 0x40018
    s_add_u32 m0, s68, 147456
    s_lshl_b32 s0, s0, 7
    s_add_u32 s0, s0, s81
    buffer_load_dwordx4 v16, s[8:11], s0 offen offset:0  lds
    v_mfma_f32_16x16x32_bf16 v[76:79], a[144:147], v[40:43], v[76:79]
    ds_read_b64_tr_b16 a[156:157], v27 offset:24576
    ds_read_b64_tr_b16 a[158:159], v27 offset:25600
    s_mul_i32 s65, s64, 55424
    v_mfma_f32_16x16x32_bf16 v[80:83], a[148:151], v[40:43], v[80:83]
    ds_read_b128 v[52:55], v23 offset:8192
    ds_read_b128 v[56:59], v23 offset:10240
    buffer_load_dwordx4 v17, s[8:11], s0 offen offset:1024  lds
    s_waitcnt lgkmcnt(6)
    v_mfma_f32_16x16x32_bf16 v[84:87], a[144:147], v[44:47], v[84:87]
    ds_read_b128 v[36:39], v23 offset:12288
    s_add_u32 s30, s65, s66
    v_mfma_f32_16x16x32_bf16 v[88:91], a[148:151], v[44:47], v[88:91]
    s_bfe_u64 s[0:1], s[76:77], 0x4001c
    s_add_u32 m0, s68, 155648
    s_lshl_b32 s0, s0, 7
    s_add_u32 s0, s0, s81
    buffer_load_dwordx4 v16, s[8:11], s0 offen offset:0  lds
    s_add_u32 s33, s30, 221696
    v_mfma_f32_16x16x32_bf16 v[92:95], a[144:147], v[48:51], v[92:95]
    ds_read_b128 v[40:43], v23 offset:14336
    s_mul_i32 s65, s64, 20480
    v_mfma_f32_16x16x32_bf16 v[96:99], a[148:151], v[48:51], v[96:99]
    buffer_load_dwordx4 v17, s[8:11], s0 offen offset:1024  lds
    s_add_u32 s94, s65, s67
    s_waitcnt lgkmcnt(2)
    v_mfma_f32_16x16x32_bf16 v[68:71], a[152:155], v[52:55], v[68:71]
    s_waitcnt lgkmcnt(0)
    s_barrier
    s_add_u32 s97, s94, 81920
    v_mfma_f32_16x16x32_bf16 v[72:75], a[156:159], v[52:55], v[72:75]
    s_bfe_u64 s[0:1], s[76:77], 0x40020
    s_add_u32 m0, s68, 16384
    s_lshl_b32 s0, s0, 7
    s_add_u32 s0, s0, s81
    buffer_load_dwordx4 v16, s[8:11], s0 offen offset:0  lds
    v_mfma_f32_16x16x32_bf16 v[76:79], a[152:155], v[56:59], v[76:79]
    v_mfma_f32_16x16x32_bf16 v[80:83], a[156:159], v[56:59], v[80:83]
    buffer_load_dwordx4 v17, s[8:11], s0 offen offset:1024  lds
    v_mfma_f32_16x16x32_bf16 v[84:87], a[152:155], v[36:39], v[84:87]
    v_mfma_f32_16x16x32_bf16 v[88:91], a[156:159], v[36:39], v[88:91]
    s_bfe_u64 s[0:1], s[76:77], 0x40024
    s_add_u32 m0, s68, 24576
    s_lshl_b32 s0, s0, 7
    s_add_u32 s0, s0, s81
    buffer_load_dwordx4 v16, s[8:11], s0 offen offset:0  lds
    v_mfma_f32_16x16x32_bf16 v[92:95], a[152:155], v[40:43], v[92:95]
    v_mfma_f32_16x16x32_bf16 v[96:99], a[156:159], v[40:43], v[96:99]
    buffer_load_dwordx4 v17, s[8:11], s0 offen offset:1024  lds
    v_readfirstlane_b32 s60, v15
    s_nop 7
    v_pk_mul_f32 v[132:133], v[68:69], v[68:69]
    v_pk_mul_f32 v[134:135], v[70:71], v[70:71]
    v_pk_mul_f32 v[136:137], v[72:73], v[72:73]
    v_pk_mul_f32 v[138:139], v[74:75], v[74:75]
    v_pk_fma_f32 v[132:133], v[132:133], s[86:87], v[8:9]
    v_pk_fma_f32 v[134:135], v[134:135], s[86:87], v[8:9]
    v_pk_fma_f32 v[136:137], v[136:137], s[86:87], v[8:9]
    v_pk_fma_f32 v[138:139], v[138:139], s[86:87], v[8:9]
    v_pk_mul_f32 v[132:133], v[132:133], v[68:69]
    v_pk_mul_f32 v[134:135], v[134:135], v[70:71]
    v_pk_mul_f32 v[136:137], v[136:137], v[72:73]
    v_pk_mul_f32 v[138:139], v[138:139], v[74:75]
    v_exp_f32_e32 v132, v132
    v_exp_f32_e32 v133, v133
    v_exp_f32_e32 v134, v134
    v_exp_f32_e32 v135, v135
    v_exp_f32_e32 v136, v136
    v_exp_f32_e32 v137, v137
    v_exp_f32_e32 v138, v138
    v_exp_f32_e32 v139, v139
    v_pk_add_f32 v[132:133], v[132:133], 1.0 op_sel_hi:[1,0]
    v_pk_add_f32 v[134:135], v[134:135], 1.0 op_sel_hi:[1,0]
    v_pk_add_f32 v[136:137], v[136:137], 1.0 op_sel_hi:[1,0]
    v_pk_add_f32 v[138:139], v[138:139], 1.0 op_sel_hi:[1,0]
    v_rcp_f32_e32 v132, v132
    v_rcp_f32_e32 v133, v133
    v_rcp_f32_e32 v134, v134
    v_rcp_f32_e32 v135, v135
    v_rcp_f32_e32 v136, v136
    v_rcp_f32_e32 v137, v137
    s_add_u32 m0, s69, 32768
    s_add_u32 s78, s78, 40960
    buffer_load_dwordx4 v200, s[24:27], s78 offen offset:0  lds
    v_rcp_f32_e32 v138, v138
    v_rcp_f32_e32 v139, v139
    v_pk_mul_f32 v[132:133], v[132:133], v[68:69]
    v_pk_mul_f32 v[134:135], v[134:135], v[70:71]
    v_pk_mul_f32 v[136:137], v[136:137], v[72:73]
    v_pk_mul_f32 v[138:139], v[138:139], v[74:75]
    v_cvt_pk_bf16_f32 v148, v132, v133
    v_cvt_pk_bf16_f32 v149, v134, v135
    v_cvt_pk_bf16_f32 v150, v136, v137
    v_cvt_pk_bf16_f32 v151, v138, v139
    buffer_store_dwordx4 v[148:151], v10, s[16:19], s82 offen sc1
    v_pk_mul_f32 v[140:141], v[76:77], v[76:77]
    v_pk_mul_f32 v[142:143], v[78:79], v[78:79]
    v_pk_mul_f32 v[144:145], v[80:81], v[80:81]
    v_pk_mul_f32 v[146:147], v[82:83], v[82:83]
    v_pk_fma_f32 v[140:141], v[140:141], s[86:87], v[8:9]
    v_pk_fma_f32 v[142:143], v[142:143], s[86:87], v[8:9]
    v_pk_fma_f32 v[144:145], v[144:145], s[86:87], v[8:9]
    v_pk_fma_f32 v[146:147], v[146:147], s[86:87], v[8:9]
    v_pk_mul_f32 v[140:141], v[140:141], v[76:77]
    v_pk_mul_f32 v[142:143], v[142:143], v[78:79]
    v_pk_mul_f32 v[144:145], v[144:145], v[80:81]
    v_pk_mul_f32 v[146:147], v[146:147], v[82:83]
    v_exp_f32_e32 v140, v140
    v_exp_f32_e32 v141, v141
    v_exp_f32_e32 v142, v142
    v_exp_f32_e32 v143, v143
    v_exp_f32_e32 v144, v144
    v_exp_f32_e32 v145, v145
    v_exp_f32_e32 v146, v146
    buffer_load_dwordx4 v201, s[24:27], s78 offen offset:1024  lds
    v_exp_f32_e32 v147, v147
    v_pk_add_f32 v[140:141], v[140:141], 1.0 op_sel_hi:[1,0]
    v_pk_add_f32 v[142:143], v[142:143], 1.0 op_sel_hi:[1,0]
    v_pk_add_f32 v[144:145], v[144:145], 1.0 op_sel_hi:[1,0]
    v_pk_add_f32 v[146:147], v[146:147], 1.0 op_sel_hi:[1,0]
    v_rcp_f32_e32 v140, v140
    v_rcp_f32_e32 v141, v141
    v_rcp_f32_e32 v142, v142
    v_rcp_f32_e32 v143, v143
    v_rcp_f32_e32 v144, v144
    v_rcp_f32_e32 v145, v145
    v_rcp_f32_e32 v146, v146
    v_rcp_f32_e32 v147, v147
    v_pk_mul_f32 v[140:141], v[140:141], v[76:77]
    v_pk_mul_f32 v[142:143], v[142:143], v[78:79]
    v_pk_mul_f32 v[144:145], v[144:145], v[80:81]
    v_pk_mul_f32 v[146:147], v[146:147], v[82:83]
    v_cvt_pk_bf16_f32 v152, v140, v141
    v_cvt_pk_bf16_f32 v153, v142, v143
    v_cvt_pk_bf16_f32 v154, v144, v145
    v_cvt_pk_bf16_f32 v155, v146, v147
    s_add_u32 s84, s82, 55424
    buffer_store_dwordx4 v[152:155], v10, s[16:19], s84 offen sc1
    v_pk_mul_f32 v[132:133], v[84:85], v[84:85]
    v_pk_mul_f32 v[134:135], v[86:87], v[86:87]
    v_pk_mul_f32 v[136:137], v[88:89], v[88:89]
    v_pk_mul_f32 v[138:139], v[90:91], v[90:91]
    v_pk_fma_f32 v[132:133], v[132:133], s[86:87], v[8:9]
    v_pk_fma_f32 v[134:135], v[134:135], s[86:87], v[8:9]
    v_pk_fma_f32 v[136:137], v[136:137], s[86:87], v[8:9]
    v_pk_fma_f32 v[138:139], v[138:139], s[86:87], v[8:9]
    buffer_load_dwordx4 v202, s[24:27], s78 offen offset:2048  lds
    v_pk_mul_f32 v[132:133], v[132:133], v[84:85]
    v_pk_mul_f32 v[134:135], v[134:135], v[86:87]
    v_pk_mul_f32 v[136:137], v[136:137], v[88:89]
    v_pk_mul_f32 v[138:139], v[138:139], v[90:91]
    v_exp_f32_e32 v132, v132
    v_exp_f32_e32 v133, v133
    v_exp_f32_e32 v134, v134
    v_exp_f32_e32 v135, v135
    v_exp_f32_e32 v136, v136
    v_exp_f32_e32 v137, v137
    v_exp_f32_e32 v138, v138
    v_exp_f32_e32 v139, v139
    v_pk_add_f32 v[132:133], v[132:133], 1.0 op_sel_hi:[1,0]
    v_pk_add_f32 v[134:135], v[134:135], 1.0 op_sel_hi:[1,0]
    v_pk_add_f32 v[136:137], v[136:137], 1.0 op_sel_hi:[1,0]
    v_pk_add_f32 v[138:139], v[138:139], 1.0 op_sel_hi:[1,0]
    v_rcp_f32_e32 v132, v132
    v_rcp_f32_e32 v133, v133
    v_rcp_f32_e32 v134, v134
    v_rcp_f32_e32 v135, v135
    v_rcp_f32_e32 v136, v136
    v_rcp_f32_e32 v137, v137
    v_rcp_f32_e32 v138, v138
    v_rcp_f32_e32 v139, v139
    v_pk_mul_f32 v[132:133], v[132:133], v[84:85]
    v_pk_mul_f32 v[134:135], v[134:135], v[86:87]
    v_pk_mul_f32 v[136:137], v[136:137], v[88:89]
    v_pk_mul_f32 v[138:139], v[138:139], v[90:91]
    v_cvt_pk_bf16_f32 v156, v132, v133
    v_cvt_pk_bf16_f32 v157, v134, v135
    buffer_load_dwordx4 v203, s[24:27], s78 offen offset:3072  lds
    v_cvt_pk_bf16_f32 v158, v136, v137
    v_cvt_pk_bf16_f32 v159, v138, v139
    s_add_u32 s84, s82, 110848
    buffer_store_dwordx4 v[156:159], v10, s[16:19], s84 offen sc1
    s_waitcnt vmcnt(7)
    s_barrier
    ds_read_b128 v[172:175], v24 offset:0
    ds_read_b128 v[176:179], v24 offset:2048
    ds_read_b128 v[180:183], v24 offset:4096
    ds_read_b128 v[184:187], v24 offset:6144
    v_pk_mul_f32 v[140:141], v[92:93], v[92:93]
    v_pk_mul_f32 v[142:143], v[94:95], v[94:95]
    v_pk_mul_f32 v[144:145], v[96:97], v[96:97]
    v_pk_mul_f32 v[146:147], v[98:99], v[98:99]
    v_pk_fma_f32 v[140:141], v[140:141], s[86:87], v[8:9]
    v_pk_fma_f32 v[142:143], v[142:143], s[86:87], v[8:9]
    v_pk_fma_f32 v[144:145], v[144:145], s[86:87], v[8:9]
    v_pk_fma_f32 v[146:147], v[146:147], s[86:87], v[8:9]
L_pg0_1:
    s_cbranch_execz L_pg0_2
    s_nop 0
    v_pk_mul_f32 v[140:141], v[140:141], v[92:93]
    v_pk_mul_f32 v[142:143], v[142:143], v[94:95]
    v_pk_mul_f32 v[144:145], v[144:145], v[96:97]
    v_pk_mul_f32 v[146:147], v[146:147], v[98:99]
    v_exp_f32_e32 v140, v140
    v_exp_f32_e32 v141, v141
    v_exp_f32_e32 v142, v142
    v_exp_f32_e32 v143, v143
    v_exp_f32_e32 v144, v144
    v_exp_f32_e32 v145, v145
    v_exp_f32_e32 v146, v146
    v_exp_f32_e32 v147, v147
    v_pk_add_f32 v[140:141], v[140:141], 1.0 op_sel_hi:[1,0]
    v_pk_add_f32 v[142:143], v[142:143], 1.0 op_sel_hi:[1,0]
    v_pk_add_f32 v[144:145], v[144:145], 1.0 op_sel_hi:[1,0]
    v_pk_add_f32 v[146:147], v[146:147], 1.0 op_sel_hi:[1,0]
    v_rcp_f32_e32 v140, v140
    v_rcp_f32_e32 v141, v141
    v_rcp_f32_e32 v142, v142
    v_rcp_f32_e32 v143, v143
    v_rcp_f32_e32 v144, v144
    v_rcp_f32_e32 v145, v145
    v_rcp_f32_e32 v146, v146
    v_rcp_f32_e32 v147, v147
    v_pk_mul_f32 v[140:141], v[140:141], v[92:93]
    v_pk_mul_f32 v[142:143], v[142:143], v[94:95]
    v_pk_mul_f32 v[144:145], v[144:145], v[96:97]
    v_pk_mul_f32 v[146:147], v[146:147], v[98:99]
    v_cvt_pk_bf16_f32 v160, v140, v141
    v_cvt_pk_bf16_f32 v161, v142, v143
    v_cvt_pk_bf16_f32 v162, v144, v145
    v_cvt_pk_bf16_f32 v163, v146, v147
    s_add_u32 s84, s82, 166272
    buffer_store_dwordx4 v[160:163], v10, s[16:19], s84 offen sc1
    s_waitcnt lgkmcnt(2)
    v_mfma_f32_16x16x32_bf16 v[100:103], a[0:3], v[172:175], v[100:103]
    ds_read_b128 v[164:167], v25 offset:0
    v_mfma_f32_16x16x32_bf16 v[104:107], a[4:7], v[172:175], v[104:107]
    s_add_u32 m0, s69, 49152
    s_add_u32 s78, s78, 40960
    buffer_load_dwordx4 v200, s[24:27], s78 offen offset:0  lds
    v_mfma_f32_16x16x32_bf16 v[108:111], a[0:3], v[176:179], v[108:111]
    ds_read_b128 v[168:171], v25 offset:2048
    v_mfma_f32_16x16x32_bf16 v[112:115], a[4:7], v[176:179], v[112:115]
    s_waitcnt lgkmcnt(2)
    v_mfma_f32_16x16x32_bf16 v[116:119], a[0:3], v[180:183], v[116:119]
    ds_read_b128 v[172:175], v25 offset:4096
    v_mfma_f32_16x16x32_bf16 v[120:123], a[4:7], v[180:183], v[120:123]
    buffer_load_dwordx4 v201, s[24:27], s78 offen offset:1024  lds
    v_mfma_f32_16x16x32_bf16 v[124:127], a[0:3], v[184:187], v[124:127]
    ds_read_b128 v[176:179], v25 offset:6144
    v_mfma_f32_16x16x32_bf16 v[128:131], a[4:7], v[184:187], v[128:131]
    s_waitcnt lgkmcnt(2)
    v_mfma_f32_16x16x32_bf16 v[100:103], a[8:11], v[164:167], v[100:103]
    ds_read_b128 v[180:183], v24 offset:8192
    v_mfma_f32_16x16x32_bf16 v[104:107], a[12:15], v[164:167], v[104:107]
    buffer_load_dwordx4 v202, s[24:27], s78 offen offset:2048  lds
    v_mfma_f32_16x16x32_bf16 v[108:111], a[8:11], v[168:171], v[108:111]
    ds_read_b128 v[184:187], v24 offset:10240
    v_mfma_f32_16x16x32_bf16 v[112:115], a[12:15], v[168:171], v[112:115]
    s_waitcnt lgkmcnt(2)
    v_mfma_f32_16x16x32_bf16 v[116:119], a[8:11], v[172:175], v[116:119]
    ds_read_b128 v[164:167], v24 offset:12288
    v_mfma_f32_16x16x32_bf16 v[120:123], a[12:15], v[172:175], v[120:123]
    buffer_load_dwordx4 v203, s[24:27], s78 offen offset:3072  lds
    v_mfma_f32_16x16x32_bf16 v[124:127], a[8:11], v[176:179], v[124:127]
    ds_read_b128 v[168:171], v24 offset:14336
    s_add_u32 m0, s69, 0
    v_mfma_f32_16x16x32_bf16 v[128:131], a[12:15], v[176:179], v[128:131]
    s_add_u32 s78, s78, 40960
    s_waitcnt lgkmcnt(2)
    v_mfma_f32_16x16x32_bf16 v[100:103], a[16:19], v[180:183], v[100:103]
    ds_read_b128 v[172:175], v25 offset:8192
    s_waitcnt vmcnt(6)
    v_mfma_f32_16x16x32_bf16 v[104:107], a[20:23], v[180:183], v[104:107]
    buffer_load_dwordx4 v200, s[24:27], s78 offen offset:0  lds
    v_mfma_f32_16x16x32_bf16 v[108:111], a[16:19], v[184:187], v[108:111]
    ds_read_b128 v[176:179], v25 offset:10240
    ds_read_b64_tr_b16 a[160:161], v208 offset:0
    v_mfma_f32_16x16x32_bf16 v[112:115], a[20:23], v[184:187], v[112:115]
    ds_read_b64_tr_b16 a[162:163], v208 offset:2048
    s_waitcnt lgkmcnt(4)
    v_mfma_f32_16x16x32_bf16 v[116:119], a[16:19], v[164:167], v[116:119]
    ds_read_b128 v[180:183], v25 offset:12288
    ds_read_b64_tr_b16 a[164:165], v209 offset:0
    v_mfma_f32_16x16x32_bf16 v[120:123], a[20:23], v[164:167], v[120:123]
    buffer_load_dwordx4 v201, s[24:27], s78 offen offset:1024  lds
    v_mfma_f32_16x16x32_bf16 v[124:127], a[16:19], v[168:171], v[124:127]
    ds_read_b128 v[184:187], v25 offset:14336
    ds_read_b64_tr_b16 a[166:167], v209 offset:2048
    v_mfma_f32_16x16x32_bf16 v[128:131], a[20:23], v[168:171], v[128:131]
    ds_read_b64_tr_b16 a[168:169], v210 offset:0
    s_waitcnt lgkmcnt(7)
    v_mfma_f32_16x16x32_bf16 v[100:103], a[24:27], v[172:175], v[100:103]
    ds_read_b128 v[164:167], v24 offset:16384
    ds_read_b64_tr_b16 a[170:171], v210 offset:2048
    v_mfma_f32_16x16x32_bf16 v[104:107], a[28:31], v[172:175], v[104:107]
    buffer_load_dwordx4 v202, s[24:27], s78 offen offset:2048  lds
    v_mfma_f32_16x16x32_bf16 v[108:111], a[24:27], v[176:179], v[108:111]
    ds_read_b128 v[168:171], v24 offset:18432
    ds_read_b64_tr_b16 a[172:173], v211 offset:0
    v_mfma_f32_16x16x32_bf16 v[112:115], a[28:31], v[176:179], v[112:115]
    ds_read_b64_tr_b16 a[174:175], v211 offset:2048
    s_waitcnt lgkmcnt(7)
    v_mfma_f32_16x16x32_bf16 v[116:119], a[24:27], v[180:183], v[116:119]
    ds_read_b128 v[172:175], v24 offset:20480
    v_mfma_f32_16x16x32_bf16 v[120:123], a[28:31], v[180:183], v[120:123]
    buffer_load_dwordx4 v203, s[24:27], s78 offen offset:3072  lds
    v_mfma_f32_16x16x32_bf16 v[124:127], a[24:27], v[184:187], v[124:127]
    ds_read_b128 v[176:179], v24 offset:22528
    s_add_u32 m0, s69, 16384
    v_mfma_f32_16x16x32_bf16 v[128:131], a[28:31], v[184:187], v[128:131]
    s_add_u32 s78, s78, 40960
    s_waitcnt lgkmcnt(4)
    v_mfma_f32_16x16x32_bf16 v[100:103], a[32:35], v[164:167], v[100:103]
    ds_read_b128 v[180:183], v25 offset:16384
    v_mfma_f32_16x16x32_bf16 v[104:107], a[36:39], v[164:167], v[104:107]
    buffer_load_dwordx4 v200, s[24:27], s78 offen offset:0  lds
    v_mfma_f32_16x16x32_bf16 v[108:111], a[32:35], v[168:171], v[108:111]
    ds_read_b128 v[184:187], v25 offset:18432
    v_mfma_f32_16x16x32_bf16 v[112:115], a[36:39], v[168:171], v[112:115]
    s_waitcnt lgkmcnt(2)
    v_mfma_f32_16x16x32_bf16 v[116:119], a[32:35], v[172:175], v[116:119]
    ds_read_b128 v[164:167], v25 offset:20480
    v_mfma_f32_16x16x32_bf16 v[120:123], a[36:39], v[172:175], v[120:123]
    buffer_load_dwordx4 v201, s[24:27], s78 offen offset:1024  lds
    v_mfma_f32_16x16x32_bf16 v[124:127], a[32:35], v[176:179], v[124:127]
    ds_read_b128 v[168:171], v25 offset:22528
    v_mfma_f32_16x16x32_bf16 v[128:131], a[36:39], v[176:179], v[128:131]
    s_waitcnt lgkmcnt(2)
    v_mfma_f32_16x16x32_bf16 v[100:103], a[40:43], v[180:183], v[100:103]
    ds_read_b128 v[172:175], v24 offset:24576
    v_mfma_f32_16x16x32_bf16 v[104:107], a[44:47], v[180:183], v[104:107]
    buffer_load_dwordx4 v202, s[24:27], s78 offen offset:2048  lds
    v_mfma_f32_16x16x32_bf16 v[108:111], a[40:43], v[184:187], v[108:111]
    ds_read_b128 v[176:179], v24 offset:26624
    v_mfma_f32_16x16x32_bf16 v[112:115], a[44:47], v[184:187], v[112:115]
    s_waitcnt lgkmcnt(2)
    v_mfma_f32_16x16x32_bf16 v[116:119], a[40:43], v[164:167], v[116:119]
    ds_read_b128 v[180:183], v24 offset:28672
    v_mfma_f32_16x16x32_bf16 v[120:123], a[44:47], v[164:167], v[120:123]
    buffer_load_dwordx4 v203, s[24:27], s78 offen offset:3072  lds
    v_mfma_f32_16x16x32_bf16 v[124:127], a[40:43], v[168:171], v[124:127]
    ds_read_b128 v[184:187], v24 offset:30720
    s_add_u32 m0, s69, -32768
    v_mfma_f32_16x16x32_bf16 v[128:131], a[44:47], v[168:171], v[128:131]
    s_add_u32 s78, s78, 40960
    s_waitcnt lgkmcnt(2)
    v_mfma_f32_16x16x32_bf16 v[100:103], a[48:51], v[172:175], v[100:103]
    ds_read_b128 v[164:167], v25 offset:24576
    v_mfma_f32_16x16x32_bf16 v[104:107], a[52:55], v[172:175], v[104:107]
    buffer_load_dwordx4 v200, s[24:27], s78 offen offset:0  lds
    v_mfma_f32_16x16x32_bf16 v[108:111], a[48:51], v[176:179], v[108:111]
    ds_read_b128 v[168:171], v25 offset:26624
    v_mfma_f32_16x16x32_bf16 v[112:115], a[52:55], v[176:179], v[112:115]
    s_waitcnt lgkmcnt(2)
    v_mfma_f32_16x16x32_bf16 v[116:119], a[48:51], v[180:183], v[116:119]
    ds_read_b128 v[172:175], v25 offset:28672
    v_mfma_f32_16x16x32_bf16 v[120:123], a[52:55], v[180:183], v[120:123]
    buffer_load_dwordx4 v201, s[24:27], s78 offen offset:1024  lds
    v_mfma_f32_16x16x32_bf16 v[124:127], a[48:51], v[184:187], v[124:127]
    ds_read_b128 v[176:179], v25 offset:30720
    v_mfma_f32_16x16x32_bf16 v[128:131], a[52:55], v[184:187], v[128:131]
    s_waitcnt lgkmcnt(2)
    v_mfma_f32_16x16x32_bf16 v[100:103], a[56:59], v[164:167], v[100:103]
    s_waitcnt lgkmcnt(0)
    s_barrier
    ds_read_b128 v[180:183], v24 offset:32768
    s_waitcnt vmcnt(10)
    v_mfma_f32_16x16x32_bf16 v[104:107], a[60:63], v[164:167], v[104:107]
    buffer_load_dwordx4 v202, s[24:27], s78 offen offset:2048  lds
    v_mfma_f32_16x16x32_bf16 v[108:111], a[56:59], v[168:171], v[108:111]
    ds_read_b128 v[184:187], v24 offset:34816
    ds_read_b64_tr_b16 a[176:177], v208 offset:16384
    v_mfma_f32_16x16x32_bf16 v[112:115], a[60:63], v[168:171], v[112:115]
    ds_read_b64_tr_b16 a[178:179], v208 offset:18432
    s_cmp_eq_u32 s60, 0
    s_cbranch_scc1 L_late_tag
L_have_tag:
    v_mov_b32 v32, s60
    s_mov_b64 exec, 0xff
    buffer_store_dwordx4 v[32:35], v10, s[16:19], s62 offen sc1
    s_mov_b64 exec, -1
    v_mfma_f32_16x16x32_bf16 v[116:119], a[56:59], v[172:175], v[116:119]
    ds_read_b128 v[164:167], v24 offset:36864
    ds_read_b64_tr_b16 a[180:181], v209 offset:16384
    v_mfma_f32_16x16x32_bf16 v[120:123], a[60:63], v[172:175], v[120:123]
    buffer_load_dwordx4 v203, s[24:27], s78 offen offset:3072  lds
    v_mfma_f32_16x16x32_bf16 v[124:127], a[56:59], v[176:179], v[124:127]
    ds_read_b128 v[168:171], v24 offset:38912
    s_add_u32 m0, s69, 65536
    v_mfma_f32_16x16x32_bf16 v[128:131], a[60:63], v[176:179], v[128:131]
    s_add_u32 s78, s78, 40960
    s_waitcnt lgkmcnt(5)
    v_mfma_f32_16x16x32_bf16 v[100:103], a[64:67], v[180:183], v[100:103]
    ds_read_b128 v[172:175], v25 offset:32768
    ds_read_b64_tr_b16 a[182:183], v209 offset:18432
    v_mfma_f32_16x16x32_bf16 v[104:107], a[68:71], v[180:183], v[104:107]
    buffer_load_dwordx4 v200, s[24:27], s78 offen offset:0  lds
    v_mfma_f32_16x16x32_bf16 v[108:111], a[64:67], v[184:187], v[108:111]
    ds_read_b128 v[176:179], v25 offset:34816
    ds_read_b64_tr_b16 a[184:185], v210 offset:16384
    v_mfma_f32_16x16x32_bf16 v[112:115], a[68:71], v[184:187], v[112:115]
    ds_read_b64_tr_b16 a[186:187], v210 offset:18432
    s_waitcnt lgkmcnt(5)
    v_mfma_f32_16x16x32_bf16 v[116:119], a[64:67], v[164:167], v[116:119]
    ds_read_b128 v[180:183], v25 offset:36864
    ds_read_b64_tr_b16 a[188:189], v211 offset:16384
    v_mfma_f32_16x16x32_bf16 v[120:123], a[68:71], v[164:167], v[120:123]
    buffer_load_dwordx4 v201, s[24:27], s78 offen offset:1024  lds
    v_mfma_f32_16x16x32_bf16 v[124:127], a[64:67], v[168:171], v[124:127]
    ds_read_b128 v[184:187], v25 offset:38912
    ds_read_b64_tr_b16 a[190:191], v211 offset:18432
    v_mfma_f32_16x16x32_bf16 v[128:131], a[68:71], v[168:171], v[128:131]
    s_waitcnt lgkmcnt(6)
    v_mfma_f32_16x16x32_bf16 v[100:103], a[72:75], v[172:175], v[100:103]
    ds_read_b128 v[164:167], v24 offset:40960
    s_waitcnt vmcnt(10)
    v_mfma_f32_16x16x32_bf16 v[104:107], a[76:79], v[172:175], v[104:107]
    buffer_load_dwordx4 v202, s[24:27], s78 offen offset:2048  lds
    v_mfma_f32_16x16x32_bf16 v[108:111], a[72:75], v[176:179], v[108:111]
    ds_read_b128 v[168:171], v24 offset:43008
    ds_read_b64_tr_b16 a[192:193], v204 offset:32768
    v_mfma_f32_16x16x32_bf16 v[112:115], a[76:79], v[176:179], v[112:115]
    ds_read_b64_tr_b16 a[194:195], v204 offset:34816
    s_waitcnt lgkmcnt(5)
    v_mfma_f32_16x16x32_bf16 v[116:119], a[72:75], v[180:183], v[116:119]
    ds_read_b128 v[172:175], v24 offset:45056
    ds_read_b64_tr_b16 a[196:197], v205 offset:32768
    v_mfma_f32_16x16x32_bf16 v[120:123], a[76:79], v[180:183], v[120:123]
    buffer_load_dwordx4 v203, s[24:27], s78 offen offset:3072  lds
    v_mfma_f32_16x16x32_bf16 v[124:127], a[72:75], v[184:187], v[124:127]
    ds_read_b128 v[176:179], v24 offset:47104
    s_add_u32 m0, s69, 81920
    v_mfma_f32_16x16x32_bf16 v[128:131], a[76:79], v[184:187], v[128:131]
    s_add_u32 s78, s78, 40960
    s_waitcnt lgkmcnt(5)
    v_mfma_f32_16x16x32_bf16 v[100:103], a[80:83], v[164:167], v[100:103]
    ds_read_b128 v[180:183], v25 offset:40960
    ds_read_b64_tr_b16 a[198:199], v205 offset:34816
    v_mfma_f32_16x16x32_bf16 v[104:107], a[84:87], v[164:167], v[104:107]
    buffer_load_dwordx4 v200, s[24:27], s78 offen offset:0  lds
    v_mfma_f32_16x16x32_bf16 v[108:111], a[80:83], v[168:171], v[108:111]
    ds_read_b128 v[184:187], v25 offset:43008
    ds_read_b64_tr_b16 a[200:201], v206 offset:32768
    v_mfma_f32_16x16x32_bf16 v[112:115], a[84:87], v[168:171], v[112:115]
    ds_read_b64_tr_b16 a[202:203], v206 offset:34816
    s_waitcnt lgkmcnt(5)
    v_mfma_f32_16x16x32_bf16 v[116:119], a[80:83], v[172:175], v[116:119]
    ds_read_b128 v[164:167], v25 offset:45056
    ds_read_b64_tr_b16 a[204:205], v207 offset:32768
    v_mfma_f32_16x16x32_bf16 v[120:123], a[84:87], v[172:175], v[120:123]
    buffer_load_dwordx4 v201, s[24:27], s78 offen offset:1024  lds
    v_mfma_f32_16x16x32_bf16 v[124:127], a[80:83], v[176:179], v[124:127]
    ds_read_b128 v[168:171], v25 offset:47104
    ds_read_b64_tr_b16 a[206:207], v207 offset:34816
    v_mfma_f32_16x16x32_bf16 v[128:131], a[84:87], v[176:179], v[128:131]
    s_waitcnt lgkmcnt(6)
    v_mfma_f32_16x16x32_bf16 v[100:103], a[88:91], v[180:183], v[100:103]
    ds_read_b128 v[172:175], v24 offset:49152
    s_waitcnt vmcnt(10)
    v_mfma_f32_16x16x32_bf16 v[104:107], a[92:95], v[180:183], v[104:107]
    buffer_load_dwordx4 v202, s[24:27], s78 offen offset:2048  lds
    v_mfma_f32_16x16x32_bf16 v[108:111], a[88:91], v[184:187], v[108:111]
    ds_read_b128 v[176:179], v24 offset:51200
    ds_read_b64_tr_b16 a[208:209], v204 offset:49152
    v_mfma_f32_16x16x32_bf16 v[112:115], a[92:95], v[184:187], v[112:115]
    ds_read_b64_tr_b16 a[210:211], v204 offset:51200
    s_waitcnt lgkmcnt(5)
    v_mfma_f32_16x16x32_bf16 v[116:119], a[88:91], v[164:167], v[116:119]
    ds_read_b128 v[180:183], v24 offset:53248
    ds_read_b64_tr_b16 a[212:213], v205 offset:49152
    v_mfma_f32_16x16x32_bf16 v[120:123], a[92:95], v[164:167], v[120:123]
    buffer_load_dwordx4 v203, s[24:27], s78 offen offset:3072  lds
    v_mfma_f32_16x16x32_bf16 v[124:127], a[88:91], v[168:171], v[124:127]
    ds_read_b128 v[184:187], v24 offset:55296
    s_add_u32 m0, s69, 32768
    v_mfma_f32_16x16x32_bf16 v[128:131], a[92:95], v[168:171], v[128:131]
    s_add_u32 s78, s78, 40960
    s_waitcnt lgkmcnt(5)
    v_mfma_f32_16x16x32_bf16 v[100:103], a[96:99], v[172:175], v[100:103]
    ds_read_b128 v[164:167], v25 offset:49152
    ds_read_b64_tr_b16 a[214:215], v205 offset:51200
    v_mfma_f32_16x16x32_bf16 v[104:107], a[100:103], v[172:175], v[104:107]
    buffer_load_dwordx4 v200, s[24:27], s78 offen offset:0  lds
    v_mfma_f32_16x16x32_bf16 v[108:111], a[96:99], v[176:179], v[108:111]
    ds_read_b128 v[168:171], v25 offset:51200
    ds_read_b64_tr_b16 a[216:217], v206 offset:49152
    v_mfma_f32_16x16x32_bf16 v[112:115], a[100:103], v[176:179], v[112:115]
    ds_read_b64_tr_b16 a[218:219], v206 offset:51200
    s_waitcnt lgkmcnt(5)
    v_mfma_f32_16x16x32_bf16 v[116:119], a[96:99], v[180:183], v[116:119]
    ds_read_b128 v[172:175], v25 offset:53248
    ds_read_b64_tr_b16 a[220:221], v207 offset:49152
    v_mfma_f32_16x16x32_bf16 v[120:123], a[100:103], v[180:183], v[120:123]
    buffer_load_dwordx4 v201, s[24:27], s78 offen offset:1024  lds
    v_mfma_f32_16x16x32_bf16 v[124:127], a[96:99], v[184:187], v[124:127]
    ds_read_b128 v[176:179], v25 offset:55296
    ds_read_b64_tr_b16 a[222:223], v207 offset:51200
    v_mfma_f32_16x16x32_bf16 v[128:131], a[100:103], v[184:187], v[128:131]
    s_waitcnt lgkmcnt(6)
    v_mfma_f32_16x16x32_bf16 v[100:103], a[104:107], v[164:167], v[100:103]
    ds_read_b128 v[180:183], v24 offset:57344
    s_waitcnt vmcnt(10)
    v_mfma_f32_16x16x32_bf16 v[104:107], a[108:111], v[164:167], v[104:107]
    buffer_load_dwordx4 v202, s[24:27], s78 offen offset:2048  lds
    v_mfma_f32_16x16x32_bf16 v[108:111], a[104:107], v[168:171], v[108:111]
    ds_read_b128 v[184:187], v24 offset:59392
    ds_read_b64_tr_b16 a[224:225], v204 offset:0
    v_mfma_f32_16x16x32_bf16 v[112:115], a[108:111], v[168:171], v[112:115]
    ds_read_b64_tr_b16 a[226:227], v204 offset:2048
    s_waitcnt lgkmcnt(5)
    v_mfma_f32_16x16x32_bf16 v[116:119], a[104:107], v[172:175], v[116:119]
    ds_read_b128 v[164:167], v24 offset:61440
    ds_read_b64_tr_b16 a[228:229], v205 offset:0
    v_mfma_f32_16x16x32_bf16 v[120:123], a[108:111], v[172:175], v[120:123]
    buffer_load_dwordx4 v203, s[24:27], s78 offen offset:3072  lds
    v_mfma_f32_16x16x32_bf16 v[124:127], a[104:107], v[176:179], v[124:127]
    ds_read_b128 v[168:171], v24 offset:63488
    s_add_u32 m0, s69, 49152
    v_mfma_f32_16x16x32_bf16 v[128:131], a[108:111], v[176:179], v[128:131]
    s_add_u32 s78, s78, 40960
    s_waitcnt lgkmcnt(5)
    v_mfma_f32_16x16x32_bf16 v[100:103], a[112:115], v[180:183], v[100:103]
    ds_read_b128 v[172:175], v25 offset:57344
    ds_read_b64_tr_b16 a[230:231], v205 offset:2048
    v_mfma_f32_16x16x32_bf16 v[104:107], a[116:119], v[180:183], v[104:107]
    buffer_load_dwordx4 v200, s[24:27], s78 offen offset:0  lds
    v_mfma_f32_16x16x32_bf16 v[108:111], a[112:115], v[184:187], v[108:111]
    ds_read_b128 v[176:179], v25 offset:59392
    ds_read_b64_tr_b16 a[232:233], v206 offset:0
    v_mfma_f32_16x16x32_bf16 v[112:115], a[116:119], v[184:187], v[112:115]
    ds_read_b64_tr_b16 a[234:235], v206 offset:2048
    s_waitcnt lgkmcnt(5)
    v_mfma_f32_16x16x32_bf16 v[116:119], a[112:115], v[164:167], v[116:119]
    ds_read_b128 v[180:183], v25 offset:61440
    ds_read_b64_tr_b16 a[236:237], v207 offset:0
    v_mfma_f32_16x16x32_bf16 v[120:123], a[116:119], v[164:167], v[120:123]
    buffer_load_dwordx4 v201, s[24:27], s78 offen offset:1024  lds
    v_mfma_f32_16x16x32_bf16 v[124:127], a[112:115], v[168:171], v[124:127]
    ds_read_b128 v[184:187], v25 offset:63488
    ds_read_b64_tr_b16 a[238:239], v207 offset:2048
    v_mfma_f32_16x16x32_bf16 v[128:131], a[116:119], v[168:171], v[128:131]
    s_waitcnt lgkmcnt(6)
    v_mfma_f32_16x16x32_bf16 v[100:103], a[120:123], v[172:175], v[100:103]
    ds_read_b128 v[164:167], v22 offset:16384
    s_waitcnt vmcnt(10)
    v_mfma_f32_16x16x32_bf16 v[104:107], a[124:127], v[172:175], v[104:107]
    buffer_load_dwordx4 v202, s[24:27], s78 offen offset:2048  lds
    v_mfma_f32_16x16x32_bf16 v[108:111], a[120:123], v[176:179], v[108:111]
    ds_read_b128 v[168:171], v22 offset:18432
    ds_read_b64_tr_b16 a[240:241], v208 offset:32768
    v_mfma_f32_16x16x32_bf16 v[112:115], a[124:127], v[176:179], v[112:115]
    ds_read_b64_tr_b16 a[242:243], v208 offset:34816
    s_waitcnt lgkmcnt(5)
    v_mfma_f32_16x16x32_bf16 v[116:119], a[120:123], v[180:183], v[116:119]
    ds_read_b128 v[172:175], v22 offset:20480
    ds_read_b64_tr_b16 a[244:245], v209 offset:32768
    v_mfma_f32_16x16x32_bf16 v[120:123], a[124:127], v[180:183], v[120:123]
    buffer_load_dwordx4 v203, s[24:27], s78 offen offset:3072  lds
    v_mfma_f32_16x16x32_bf16 v[124:127], a[120:123], v[184:187], v[124:127]
    ds_read_b128 v[176:179], v22 offset:22528
    s_add_u32 m0, s69, 0
    v_mfma_f32_16x16x32_bf16 v[128:131], a[124:127], v[184:187], v[128:131]
    s_add_u32 s78, s78, 40960
    s_waitcnt lgkmcnt(5)
    v_mfma_f32_16x16x32_bf16 v[100:103], a[128:131], v[164:167], v[100:103]
    ds_read_b128 v[180:183], v23 offset:16384
    ds_read_b64_tr_b16 a[246:247], v209 offset:34816
    v_mfma_f32_16x16x32_bf16 v[104:107], a[132:135], v[164:167], v[104:107]
    buffer_load_dwordx4 v200, s[24:27], s78 offen offset:0  lds
    v_mfma_f32_16x16x32_bf16 v[108:111], a[128:131], v[168:171], v[108:111]
    ds_read_b128 v[184:187], v23 offset:18432
    ds_read_b64_tr_b16 a[248:249], v210 offset:32768
    v_mfma_f32_16x16x32_bf16 v[112:115], a[132:135], v[168:171], v[112:115]
    ds_read_b64_tr_b16 a[250:251], v210 offset:34816
    s_waitcnt lgkmcnt(5)
    v_mfma_f32_16x16x32_bf16 v[116:119], a[128:131], v[172:175], v[116:119]
    ds_read_b128 v[164:167], v23 offset:20480
    ds_read_b64_tr_b16 a[252:253], v211 offset:32768
    v_mfma_f32_16x16x32_bf16 v[120:123], a[132:135], v[172:175], v[120:123]
    buffer_load_dwordx4 v201, s[24:27], s78 offen offset:1024  lds
    v_mfma_f32_16x16x32_bf16 v[124:127], a[128:131], v[176:179], v[124:127]
    ds_read_b128 v[168:171], v23 offset:22528
    ds_read_b64_tr_b16 a[254:255], v211 offset:34816
    v_mfma_f32_16x16x32_bf16 v[128:131], a[132:135], v[176:179], v[128:131]
    s_waitcnt lgkmcnt(6)
    v_mfma_f32_16x16x32_bf16 v[100:103], a[136:139], v[180:183], v[100:103]
    ds_read_b128 v[172:175], v22 offset:24576
    s_waitcnt vmcnt(10)
    v_mfma_f32_16x16x32_bf16 v[104:107], a[140:143], v[180:183], v[104:107]
    buffer_load_dwordx4 v202, s[24:27], s78 offen offset:2048  lds
    v_mfma_f32_16x16x32_bf16 v[108:111], a[136:139], v[184:187], v[108:111]
    ds_read_b128 v[176:179], v22 offset:26624
    ds_read_b64_tr_b16 a[0:1], v208 offset:49152
    v_mfma_f32_16x16x32_bf16 v[112:115], a[140:143], v[184:187], v[112:115]
    ds_read_b64_tr_b16 a[2:3], v208 offset:51200
    s_waitcnt lgkmcnt(5)
    v_mfma_f32_16x16x32_bf16 v[116:119], a[136:139], v[164:167], v[116:119]
    ds_read_b128 v[180:183], v22 offset:28672
    ds_read_b64_tr_b16 a[4:5], v209 offset:49152
    v_mfma_f32_16x16x32_bf16 v[120:123], a[140:143], v[164:167], v[120:123]
    buffer_load_dwordx4 v203, s[24:27], s78 offen offset:3072  lds
    v_mfma_f32_16x16x32_bf16 v[124:127], a[136:139], v[168:171], v[124:127]
    ds_read_b128 v[184:187], v22 offset:30720
    s_add_u32 m0, s69, 16384
    v_mfma_f32_16x16x32_bf16 v[128:131], a[140:143], v[168:171], v[128:131]
    s_add_u32 s78, s78, 40960
    s_waitcnt lgkmcnt(5)
    v_mfma_f32_16x16x32_bf16 v[100:103], a[144:147], v[172:175], v[100:103]
    ds_read_b128 v[164:167], v23 offset:24576
    ds_read_b64_tr_b16 a[6:7], v209 offset:51200
    v_mfma_f32_16x16x32_bf16 v[104:107], a[148:151], v[172:175], v[104:107]
    buffer_load_dwordx4 v200, s[24:27], s78 offen offset:0  lds
    v_mfma_f32_16x16x32_bf16 v[108:111], a[144:147], v[176:179], v[108:111]
    ds_read_b128 v[168:171], v23 offset:26624
    ds_read_b64_tr_b16 a[8:9], v210 offset:49152
    v_mfma_f32_16x16x32_bf16 v[112:115], a[148:151], v[176:179], v[112:115]
    ds_read_b64_tr_b16 a[10:11], v210 offset:51200
    s_waitcnt lgkmcnt(5)
    v_mfma_f32_16x16x32_bf16 v[116:119], a[144:147], v[180:183], v[116:119]
    ds_read_b128 v[172:175], v23 offset:28672
    ds_read_b64_tr_b16 a[12:13], v211 offset:49152
    v_mfma_f32_16x16x32_bf16 v[120:123], a[148:151], v[180:183], v[120:123]
    buffer_load_dwordx4 v201, s[24:27], s78 offen offset:1024  lds
    v_mfma_f32_16x16x32_bf16 v[124:127], a[144:147], v[184:187], v[124:127]
    ds_read_b128 v[176:179], v23 offset:30720
    ds_read_b64_tr_b16 a[14:15], v211 offset:51200
    v_mfma_f32_16x16x32_bf16 v[128:131], a[148:151], v[184:187], v[128:131]
    s_waitcnt lgkmcnt(6)
    v_mfma_f32_16x16x32_bf16 v[100:103], a[152:155], v[164:167], v[100:103]
    s_waitcnt lgkmcnt(1)
    s_barrier
    v_mfma_f32_16x16x32_bf16 v[104:107], a[156:159], v[164:167], v[104:107]
    buffer_load_dwordx4 v202, s[24:27], s78 offen offset:2048  lds
    v_mfma_f32_16x16x32_bf16 v[108:111], a[152:155], v[168:171], v[108:111]
    v_mfma_f32_16x16x32_bf16 v[112:115], a[156:159], v[168:171], v[112:115]
    v_mfma_f32_16x16x32_bf16 v[116:119], a[152:155], v[172:175], v[116:119]
    v_mfma_f32_16x16x32_bf16 v[120:123], a[156:159], v[172:175], v[120:123]
    buffer_load_dwordx4 v203, s[24:27], s78 offen offset:3072  lds
    v_mfma_f32_16x16x32_bf16 v[124:127], a[152:155], v[176:179], v[124:127]
    s_add_u32 m0, s69, 98304
    v_mfma_f32_16x16x32_bf16 v[128:131], a[156:159], v[176:179], v[128:131]
    s_add_u32 s78, s78, 40960
    buffer_load_dword v12, v13, s[16:19], 0 offen sc1
    s_nop 7
    s_nop 1
    v_pk_mul_f32 v[68:69], v[100:101], v[100:101]
    v_pk_mul_f32 v[70:71], v[102:103], v[102:103]
    v_pk_mul_f32 v[72:73], v[104:105], v[104:105]
    v_pk_mul_f32 v[74:75], v[106:107], v[106:107]
    v_pk_fma_f32 v[68:69], v[68:69], s[86:87], v[8:9]
    v_pk_fma_f32 v[70:71], v[70:71], s[86:87], v[8:9]
    v_pk_fma_f32 v[72:73], v[72:73], s[86:87], v[8:9]
    v_pk_fma_f32 v[74:75], v[74:75], s[86:87], v[8:9]
    v_pk_mul_f32 v[68:69], v[68:69], v[100:101]
    v_pk_mul_f32 v[70:71], v[70:71], v[102:103]
    buffer_load_dwordx4 v200, s[24:27], s78 offen offset:0  lds
    v_pk_mul_f32 v[72:73], v[72:73], v[104:105]
    v_pk_mul_f32 v[74:75], v[74:75], v[106:107]
    v_exp_f32_e32 v68, v68
    v_exp_f32_e32 v69, v69
    v_exp_f32_e32 v70, v70
    v_exp_f32_e32 v71, v71
    v_exp_f32_e32 v72, v72
    v_exp_f32_e32 v73, v73
    v_exp_f32_e32 v74, v74
    v_exp_f32_e32 v75, v75
    buffer_load_dwordx4 v201, s[24:27], s78 offen offset:1024  lds
    v_pk_add_f32 v[68:69], v[68:69], 1.0 op_sel_hi:[1,0]
    v_pk_add_f32 v[70:71], v[70:71], 1.0 op_sel_hi:[1,0]
    v_pk_add_f32 v[72:73], v[72:73], 1.0 op_sel_hi:[1,0]
    v_pk_add_f32 v[74:75], v[74:75], 1.0 op_sel_hi:[1,0]
    v_rcp_f32_e32 v68, v68
    v_rcp_f32_e32 v69, v69
    v_rcp_f32_e32 v70, v70
    v_rcp_f32_e32 v71, v71
    v_rcp_f32_e32 v72, v72
    v_rcp_f32_e32 v73, v73
    buffer_load_dwordx4 v202, s[24:27], s78 offen offset:2048  lds
    v_rcp_f32_e32 v74, v74
    v_rcp_f32_e32 v75, v75
    v_pk_mul_f32 v[68:69], v[68:69], v[100:101]
    v_pk_mul_f32 v[70:71], v[70:71], v[102:103]
    v_pk_mul_f32 v[72:73], v[72:73], v[104:105]
    v_pk_mul_f32 v[74:75], v[74:75], v[106:107]
    v_cvt_pk_bf16_f32 v84, v68, v69
    v_cvt_pk_bf16_f32 v85, v70, v71
    v_cvt_pk_bf16_f32 v86, v72, v73
    v_cvt_pk_bf16_f32 v87, v74, v75
    buffer_load_dwordx4 v203, s[24:27], s78 offen offset:3072  lds
    buffer_store_dwordx4 v[84:87], v10, s[16:19], s83 offen sc1
    v_pk_mul_f32 v[76:77], v[108:109], v[108:109]
    v_pk_mul_f32 v[78:79], v[110:111], v[110:111]
    v_pk_mul_f32 v[80:81], v[112:113], v[112:113]
    v_pk_mul_f32 v[82:83], v[114:115], v[114:115]
    v_pk_fma_f32 v[76:77], v[76:77], s[86:87], v[8:9]
    v_pk_fma_f32 v[78:79], v[78:79], s[86:87], v[8:9]
    v_pk_fma_f32 v[80:81], v[80:81], s[86:87], v[8:9]
    v_pk_fma_f32 v[82:83], v[82:83], s[86:87], v[8:9]
    v_pk_mul_f32 v[76:77], v[76:77], v[108:109]
    s_add_u32 m0, s69, 114688
    s_add_u32 s78, s78, 40960
    buffer_load_dwordx4 v200, s[24:27], s78 offen offset:0  lds
    v_pk_mul_f32 v[78:79], v[78:79], v[110:111]
    v_pk_mul_f32 v[80:81], v[80:81], v[112:113]
    v_pk_mul_f32 v[82:83], v[82:83], v[114:115]
    v_exp_f32_e32 v76, v76
    v_exp_f32_e32 v77, v77
    v_exp_f32_e32 v78, v78
    v_exp_f32_e32 v79, v79
    v_exp_f32_e32 v80, v80
    v_exp_f32_e32 v81, v81
    v_exp_f32_e32 v82, v82
    buffer_load_dwordx4 v201, s[24:27], s78 offen offset:1024  lds
    v_exp_f32_e32 v83, v83
    v_pk_add_f32 v[76:77], v[76:77], 1.0 op_sel_hi:[1,0]
    v_pk_add_f32 v[78:79], v[78:79], 1.0 op_sel_hi:[1,0]
    v_pk_add_f32 v[80:81], v[80:81], 1.0 op_sel_hi:[1,0]
    v_pk_add_f32 v[82:83], v[82:83], 1.0 op_sel_hi:[1,0]
    v_rcp_f32_e32 v76, v76
    v_rcp_f32_e32 v77, v77
    v_rcp_f32_e32 v78, v78
    v_rcp_f32_e32 v79, v79
    v_rcp_f32_e32 v80, v80
    buffer_load_dwordx4 v202, s[24:27], s78 offen offset:2048  lds
    v_rcp_f32_e32 v81, v81
    v_rcp_f32_e32 v82, v82
    v_rcp_f32_e32 v83, v83
    v_pk_mul_f32 v[76:77], v[76:77], v[108:109]
    v_pk_mul_f32 v[78:79], v[78:79], v[110:111]
    v_pk_mul_f32 v[80:81], v[80:81], v[112:113]
    v_pk_mul_f32 v[82:83], v[82:83], v[114:115]
    v_cvt_pk_bf16_f32 v88, v76, v77
    v_cvt_pk_bf16_f32 v89, v78, v79
    v_cvt_pk_bf16_f32 v90, v80, v81
    buffer_load_dwordx4 v203, s[24:27], s78 offen offset:3072  lds
    v_cvt_pk_bf16_f32 v91, v82, v83
    s_add_u32 s84, s83, 55424
    buffer_store_dwordx4 v[88:91], v10, s[16:19], s84 offen sc1
    v_pk_mul_f32 v[68:69], v[116:117], v[116:117]
    v_pk_mul_f32 v[70:71], v[118:119], v[118:119]
    v_pk_mul_f32 v[72:73], v[120:121], v[120:121]
    v_pk_mul_f32 v[74:75], v[122:123], v[122:123]
    v_pk_fma_f32 v[68:69], v[68:69], s[86:87], v[8:9]
    v_pk_fma_f32 v[70:71], v[70:71], s[86:87], v[8:9]
    v_pk_fma_f32 v[72:73], v[72:73], s[86:87], v[8:9]
    v_pk_fma_f32 v[74:75], v[74:75], s[86:87], v[8:9]
    s_add_u32 m0, s69, -16384
    s_add_u32 s78, s78, 40960
    buffer_load_dwordx4 v200, s[24:27], s78 offen offset:0  lds
    v_pk_mul_f32 v[68:69], v[68:69], v[116:117]
    v_pk_mul_f32 v[70:71], v[70:71], v[118:119]
    v_pk_mul_f32 v[72:73], v[72:73], v[120:121]
    v_pk_mul_f32 v[74:75], v[74:75], v[122:123]
    v_exp_f32_e32 v68, v68
    v_exp_f32_e32 v69, v69
    v_exp_f32_e32 v70, v70
    v_exp_f32_e32 v71, v71
    v_exp_f32_e32 v72, v72
    v_exp_f32_e32 v73, v73
    buffer_load_dwordx4 v201, s[24:27], s78 offen offset:1024  lds
    v_exp_f32_e32 v74, v74
    v_exp_f32_e32 v75, v75
    v_pk_add_f32 v[68:69], v[68:69], 1.0 op_sel_hi:[1,0]
    v_pk_add_f32 v[70:71], v[70:71], 1.0 op_sel_hi:[1,0]
    v_pk_add_f32 v[72:73], v[72:73], 1.0 op_sel_hi:[1,0]
    v_pk_add_f32 v[74:75], v[74:75], 1.0 op_sel_hi:[1,0]
L_pg0_2:
    s_cbranch_execz L_pg0_3
    s_nop 0
    v_rcp_f32_e32 v68, v68
    v_rcp_f32_e32 v69, v69
    v_rcp_f32_e32 v70, v70
    v_rcp_f32_e32 v71, v71
    buffer_load_dwordx4 v202, s[24:27], s78 offen offset:2048  lds
    v_rcp_f32_e32 v72, v72
    v_rcp_f32_e32 v73, v73
    v_rcp_f32_e32 v74, v74
    v_rcp_f32_e32 v75, v75
    v_pk_mul_f32 v[68:69], v[68:69], v[116:117]
    v_pk_mul_f32 v[70:71], v[70:71], v[118:119]
    v_pk_mul_f32 v[72:73], v[72:73], v[120:121]
    v_pk_mul_f32 v[74:75], v[74:75], v[122:123]
    v_cvt_pk_bf16_f32 v92, v68, v69
    v_cvt_pk_bf16_f32 v93, v70, v71
    v_cvt_pk_bf16_f32 v94, v72, v73
    v_cvt_pk_bf16_f32 v95, v74, v75
    s_add_u32 s84, s83, 110848
    buffer_store_dwordx4 v[92:95], v10, s[16:19], s84 offen sc1
    v_pk_mul_f32 v[76:77], v[124:125], v[124:125]
    v_pk_mul_f32 v[78:79], v[126:127], v[126:127]
    v_pk_mul_f32 v[80:81], v[128:129], v[128:129]
    v_pk_mul_f32 v[82:83], v[130:131], v[130:131]
    v_pk_fma_f32 v[76:77], v[76:77], s[86:87], v[8:9]
    v_pk_fma_f32 v[78:79], v[78:79], s[86:87], v[8:9]
    v_pk_fma_f32 v[80:81], v[80:81], s[86:87], v[8:9]
    v_pk_fma_f32 v[82:83], v[82:83], s[86:87], v[8:9]
    v_pk_mul_f32 v[76:77], v[76:77], v[124:125]
    v_pk_mul_f32 v[78:79], v[78:79], v[126:127]
    v_pk_mul_f32 v[80:81], v[80:81], v[128:129]
    v_pk_mul_f32 v[82:83], v[82:83], v[130:131]
    v_exp_f32_e32 v76, v76
    v_exp_f32_e32 v77, v77
    v_exp_f32_e32 v78, v78
    v_exp_f32_e32 v79, v79
    v_exp_f32_e32 v80, v80
    v_exp_f32_e32 v81, v81
    v_exp_f32_e32 v82, v82
    v_exp_f32_e32 v83, v83
    v_pk_add_f32 v[76:77], v[76:77], 1.0 op_sel_hi:[1,0]
    v_pk_add_f32 v[78:79], v[78:79], 1.0 op_sel_hi:[1,0]
    v_pk_add_f32 v[80:81], v[80:81], 1.0 op_sel_hi:[1,0]
    v_pk_add_f32 v[82:83], v[82:83], 1.0 op_sel_hi:[1,0]
    v_rcp_f32_e32 v76, v76
    v_rcp_f32_e32 v77, v77
    v_rcp_f32_e32 v78, v78
    v_rcp_f32_e32 v79, v79
    v_rcp_f32_e32 v80, v80
    v_rcp_f32_e32 v81, v81
    v_rcp_f32_e32 v82, v82
    v_rcp_f32_e32 v83, v83
    v_pk_mul_f32 v[76:77], v[76:77], v[124:125]
    v_pk_mul_f32 v[78:79], v[78:79], v[126:127]
    v_pk_mul_f32 v[80:81], v[80:81], v[128:129]
    v_pk_mul_f32 v[82:83], v[82:83], v[130:131]
    v_cvt_pk_bf16_f32 v96, v76, v77
    v_cvt_pk_bf16_f32 v97, v78, v79
    v_cvt_pk_bf16_f32 v98, v80, v81
    v_cvt_pk_bf16_f32 v99, v82, v83
    s_add_u32 s84, s83, 166272
    buffer_store_dwordx4 v[96:99], v10, s[16:19], s84 offen sc1
    buffer_load_dwordx4 v203, s[24:27], s78 offen offset:3072  lds
    s_cmp_lg_u32 s80, 0
    s_cbranch_scc1 L_nop2
    s_waitcnt vmcnt(16)
    v_cmp_ne_u32 s[90:91], s60, v12
    s_nop 0
    s_cmp_eq_u64 s[90:91], 0
    s_cbranch_scc0 L_f0_slow
    s_add_u32 s79, s28, 0
    buffer_load_dwordx4 v[132:135], v10, s[16:19], s79 offen offset:0 sc1
    buffer_load_dwordx4 v[136:139], v10, s[16:19], s79 offen offset:1024 sc1
    buffer_load_dwordx4 v[140:143], v10, s[16:19], s79 offen offset:2048 sc1
    buffer_load_dwordx4 v[144:147], v10, s[16:19], s79 offen offset:3072 sc1
    s_add_u32 s79, s28, 4096
    buffer_load_dwordx4 v[148:151], v10, s[16:19], s79 offen offset:0 sc1
    buffer_load_dwordx4 v[152:155], v10, s[16:19], s79 offen offset:1024 sc1
    buffer_load_dwordx4 v[156:159], v10, s[16:19], s79 offen offset:2048 sc1
    buffer_load_dwordx4 v[160:163], v10, s[16:19], s79 offen offset:3072 sc1
    ds_read_b64_tr_b16 a[16:17], v208 offset:0
    ds_read_b64_tr_b16 a[18:19], v208 offset:2048
    ds_read_b64_tr_b16 a[20:21], v209 offset:0
    ds_read_b64_tr_b16 a[22:23], v209 offset:2048
    ds_read_b64_tr_b16 a[24:25], v210 offset:0
    ds_read_b64_tr_b16 a[26:27], v210 offset:2048
    ds_read_b64_tr_b16 a[28:29], v211 offset:0
    ds_read_b64_tr_b16 a[30:31], v211 offset:2048
    ds_read_b64_tr_b16 a[32:33], v208 offset:16384
    ds_read_b64_tr_b16 a[34:35], v208 offset:18432
    ds_read_b64_tr_b16 a[36:37], v209 offset:16384
    ds_read_b64_tr_b16 a[38:39], v209 offset:18432
    ds_read_b64_tr_b16 a[40:41], v210 offset:16384
    ds_read_b64_tr_b16 a[42:43], v210 offset:18432
    s_waitcnt lgkmcnt(8)
    ds_read_b64_tr_b16 a[44:45], v211 offset:16384
    ds_read_b64_tr_b16 a[46:47], v211 offset:18432
    ds_read_b64_tr_b16 a[48:49], v204 offset:32768
    ds_read_b64_tr_b16 a[50:51], v204 offset:34816
    ds_read_b64_tr_b16 a[52:53], v205 offset:32768
    ds_read_b64_tr_b16 a[54:55], v205 offset:34816
    ds_read_b64_tr_b16 a[56:57], v206 offset:32768
    s_waitcnt lgkmcnt(8)
    ds_read_b64_tr_b16 a[58:59], v206 offset:34816
    ds_read_b64_tr_b16 a[60:61], v207 offset:32768
    ds_read_b64_tr_b16 a[62:63], v207 offset:34816
    ds_read_b64_tr_b16 a[64:65], v204 offset:49152
    ds_read_b64_tr_b16 a[66:67], v204 offset:51200
    ds_read_b64_tr_b16 a[68:69], v205 offset:49152
    ds_read_b64_tr_b16 a[70:71], v205 offset:51200
    s_waitcnt lgkmcnt(8)
    ds_read_b64_tr_b16 a[72:73], v206 offset:49152
    ds_read_b64_tr_b16 a[74:75], v206 offset:51200
    ds_read_b64_tr_b16 a[76:77], v207 offset:49152
    ds_read_b64_tr_b16 a[78:79], v207 offset:51200
    s_mov_b64 exec, 0
    s_mov_b32 s63, 1
    s_branch L_pg1_0
L_pg1_1:
L_pgret1:
    s_cmp_eq_u32 s63, 1
    s_cbranch_scc1 L_pgback1
    s_endpgm
L_pgback1:
    s_mov_b32 s63, 0
    s_mov_b64 exec, -1
    s_mov_b64 exec, 0xff
    s_waitcnt vmcnt(9)
    buffer_store_dwordx4 v[32:35], v10, s[16:19], s88 offen sc1
    s_mov_b64 exec, -1
L_rest:
    s_waitcnt vmcnt(7) lgkmcnt(0)
    v_mfma_f32_16x16x32_bf16 v[36:39], a[160:163], v[132:135], v[224:227]
    s_add_u32 s79, s28, 8192
    buffer_load_dwordx4 v[164:167], v10, s[16:19], s79 offen offset:0 sc1
    v_mfma_f32_16x16x32_bf16 v[40:43], a[164:167], v[132:135], v[228:231]
    ds_read_b64_tr_b16 a[80:81], v212 offset:0
    ds_read_b64_tr_b16 a[82:83], v212 offset:2048
    v_mfma_f32_16x16x32_bf16 v[44:47], a[168:171], v[132:135], v[232:235]
    ds_read_b64_tr_b16 a[84:85], v213 offset:0
    ds_read_b64_tr_b16 a[86:87], v213 offset:2048
    v_mfma_f32_16x16x32_bf16 v[48:51], a[172:175], v[132:135], v[236:239]
    buffer_load_dwordx4 v[168:171], v10, s[16:19], s79 offen offset:1024 sc1
    s_waitcnt vmcnt(8)
    v_mfma_f32_16x16x32_bf16 v[36:39], a[176:179], v[136:139], v[36:39]
    buffer_load_dwordx4 v[172:175], v10, s[16:19], s79 offen offset:2048 sc1
    v_mfma_f32_16x16x32_bf16 v[40:43], a[180:183], v[136:139], v[40:43]
    ds_read_b64_tr_b16 a[88:89], v214 offset:0
    ds_read_b64_tr_b16 a[90:91], v214 offset:2048
    v_mfma_f32_16x16x32_bf16 v[44:47], a[184:187], v[136:139], v[44:47]
    ds_read_b64_tr_b16 a[92:93], v215 offset:0
    ds_read_b64_tr_b16 a[94:95], v215 offset:2048
    v_mfma_f32_16x16x32_bf16 v[48:51], a[188:191], v[136:139], v[48:51]
    buffer_load_dwordx4 v[176:179], v10, s[16:19], s79 offen offset:3072 sc1
    s_waitcnt vmcnt(9)
    v_mfma_f32_16x16x32_bf16 v[36:39], a[192:195], v[140:143], v[36:39]
    s_add_u32 s79, s28, 12288
    buffer_load_dwordx4 v[180:183], v11, s[16:19], s79 offen offset:0 sc1
    v_mfma_f32_16x16x32_bf16 v[40:43], a[196:199], v[140:143], v[40:43]
    ds_read_b64_tr_b16 a[96:97], v212 offset:16384
    ds_read_b64_tr_b16 a[98:99], v212 offset:18432
    v_mfma_f32_16x16x32_bf16 v[44:47], a[200:203], v[140:143], v[44:47]
    ds_read_b64_tr_b16 a[100:101], v213 offset:16384
    ds_read_b64_tr_b16 a[102:103], v213 offset:18432
    v_mfma_f32_16x16x32_bf16 v[48:51], a[204:207], v[140:143], v[48:51]
    buffer_load_dwordx4 v[184:187], v11, s[16:19], s79 offen offset:1024 sc1
    s_waitcnt vmcnt(10)
    v_mfma_f32_16x16x32_bf16 v[36:39], a[208:211], v[144:147], v[36:39]
    s_add_u32 s79, s29, 0
    buffer_load_dwordx4 v[188:191], v10, s[16:19], s79 offen offset:0 sc1
    v_mfma_f32_16x16x32_bf16 v[40:43], a[212:215], v[144:147], v[40:43]
    ds_read_b64_tr_b16 a[104:105], v214 offset:16384
    ds_read_b64_tr_b16 a[106:107], v214 offset:18432
    v_mfma_f32_16x16x32_bf16 v[44:47], a[216:219], v[144:147], v[44:47]
    ds_read_b64_tr_b16 a[108:109], v215 offset:16384
    s_waitcnt lgkmcnt(8)
    ds_read_b64_tr_b16 a[110:111], v215 offset:18432
    v_mfma_f32_16x16x32_bf16 v[48:51], a[220:223], v[144:147], v[48:51]
    buffer_load_dwordx4 v[192:195], v10, s[16:19], s79 offen offset:1024 sc1
    s_waitcnt vmcnt(11)
    v_mfma_f32_16x16x32_bf16 v[36:39], a[224:227], v[148:151], v[36:39]
    buffer_load_dwordx4 v[132:135], v10, s[16:19], s79 offen offset:2048 sc1
    v_mfma_f32_16x16x32_bf16 v[40:43], a[228:231], v[148:151], v[40:43]
    ds_read_b64_tr_b16 a[112:113], v204 offset:16384
    ds_read_b64_tr_b16 a[114:115], v204 offset:18432
    v_mfma_f32_16x16x32_bf16 v[44:47], a[232:235], v[148:151], v[44:47]
    ds_read_b64_tr_b16 a[116:117], v205 offset:16384
    ds_read_b64_tr_b16 a[118:119], v205 offset:18432
    v_mfma_f32_16x16x32_bf16 v[48:51], a[236:239], v[148:151], v[48:51]
    buffer_load_dwordx4 v[136:139], v10, s[16:19], s79 offen offset:3072 sc1
    s_waitcnt vmcnt(12)
    v_mfma_f32_16x16x32_bf16 v[36:39], a[240:243], v[152:155], v[36:39]
    s_add_u32 s79, s29, 4096
    buffer_load_dwordx4 v[140:143], v10, s[16:19], s79 offen offset:0 sc1
    v_mfma_f32_16x16x32_bf16 v[40:43], a[244:247], v[152:155], v[40:43]
    ds_read_b64_tr_b16 a[120:121], v206 offset:16384
    ds_read_b64_tr_b16 a[122:123], v206 offset:18432
    v_mfma_f32_16x16x32_bf16 v[44:47], a[248:251], v[152:155], v[44:47]
    s_waitcnt lgkmcnt(8)
    ds_read_b64_tr_b16 a[124:125], v207 offset:16384
    ds_read_b64_tr_b16 a[126:127], v207 offset:18432
    v_mfma_f32_16x16x32_bf16 v[48:51], a[252:255], v[152:155], v[48:51]
    buffer_load_dwordx4 v[144:147], v10, s[16:19], s79 offen offset:1024 sc1
    s_waitcnt vmcnt(13)
    v_mfma_f32_16x16x32_bf16 v[36:39], a[0:3], v[156:159], v[36:39]
    buffer_load_dwordx4 v[148:151], v10, s[16:19], s79 offen offset:2048 sc1
    v_mfma_f32_16x16x32_bf16 v[40:43], a[4:7], v[156:159], v[40:43]
    v_mfma_f32_16x16x32_bf16 v[44:47], a[8:11], v[156:159], v[44:47]
    v_mfma_f32_16x16x32_bf16 v[48:51], a[12:15], v[156:159], v[48:51]
    s_waitcnt vmcnt(13)
    v_mfma_f32_16x16x32_bf16 v[36:39], a[16:19], v[160:163], v[36:39]
    buffer_load_dwordx4 v[152:155], v10, s[16:19], s79 offen offset:3072 sc1
    v_mfma_f32_16x16x32_bf16 v[40:43], a[20:23], v[160:163], v[40:43]
    v_mfma_f32_16x16x32_bf16 v[44:47], a[24:27], v[160:163], v[44:47]
    v_mfma_f32_16x16x32_bf16 v[48:51], a[28:31], v[160:163], v[48:51]
    s_waitcnt vmcnt(13)
    v_mfma_f32_16x16x32_bf16 v[36:39], a[32:35], v[164:167], v[36:39]
    s_add_u32 s79, s29, 8192
    buffer_load_dwordx4 v[156:159], v10, s[16:19], s79 offen offset:0 sc1
    v_mfma_f32_16x16x32_bf16 v[40:43], a[36:39], v[164:167], v[40:43]
    v_mfma_f32_16x16x32_bf16 v[44:47], a[40:43], v[164:167], v[44:47]
    v_mfma_f32_16x16x32_bf16 v[48:51], a[44:47], v[164:167], v[48:51]
    s_waitcnt vmcnt(13)
    v_mfma_f32_16x16x32_bf16 v[36:39], a[48:51], v[168:171], v[36:39]
    buffer_load_dwordx4 v[160:163], v10, s[16:19], s79 offen offset:1024 sc1
    v_mfma_f32_16x16x32_bf16 v[40:43], a[52:55], v[168:171], v[40:43]
    v_mfma_f32_16x16x32_bf16 v[44:47], a[56:59], v[168:171], v[44:47]
    v_mfma_f32_16x16x32_bf16 v[48:51], a[60:63], v[168:171], v[48:51]
    s_waitcnt vmcnt(13)
    v_mfma_f32_16x16x32_bf16 v[36:39], a[64:67], v[172:175], v[36:39]
    buffer_load_dwordx4 v[164:167], v10, s[16:19], s79 offen offset:2048 sc1
    v_mfma_f32_16x16x32_bf16 v[40:43], a[68:71], v[172:175], v[40:43]
    v_mfma_f32_16x16x32_bf16 v[44:47], a[72:75], v[172:175], v[44:47]
    v_mfma_f32_16x16x32_bf16 v[48:51], a[76:79], v[172:175], v[48:51]
    s_waitcnt vmcnt(13)
    v_mfma_f32_16x16x32_bf16 v[36:39], a[80:83], v[176:179], v[36:39]
    buffer_load_dwordx4 v[168:171], v10, s[16:19], s79 offen offset:3072 sc1
    v_mfma_f32_16x16x32_bf16 v[40:43], a[84:87], v[176:179], v[40:43]
    v_mfma_f32_16x16x32_bf16 v[44:47], a[88:91], v[176:179], v[44:47]
    s_add_u32 s79, s29, 12288
    v_mfma_f32_16x16x32_bf16 v[48:51], a[92:95], v[176:179], v[48:51]
    s_waitcnt vmcnt(13)
    s_waitcnt lgkmcnt(8)
    v_mfma_f32_16x16x32_bf16 v[36:39], a[96:99], v[180:183], v[36:39]
    buffer_load_dwordx4 v[172:175], v11, s[16:19], s79 offen offset:0 sc1
    v_mfma_f32_16x16x32_bf16 v[40:43], a[100:103], v[180:183], v[40:43]
    v_mfma_f32_16x16x32_bf16 v[44:47], a[104:107], v[180:183], v[44:47]
    v_mfma_f32_16x16x32_bf16 v[48:51], a[108:111], v[180:183], v[48:51]
    s_waitcnt vmcnt(13)
    s_waitcnt lgkmcnt(0)
    v_mfma_f32_16x16x32_bf16 v[36:39], a[112:115], v[184:187], v[36:39]
    buffer_load_dwordx4 v[176:179], v11, s[16:19], s79 offen offset:1024 sc1
    v_mfma_f32_16x16x32_bf16 v[40:43], a[116:119], v[184:187], v[40:43]
    v_mfma_f32_16x16x32_bf16 v[44:47], a[120:123], v[184:187], v[44:47]
    s_add_u32 s79, s30, 0
    v_mfma_f32_16x16x32_bf16 v[48:51], a[124:127], v[184:187], v[48:51]
    s_waitcnt vmcnt(13)
    v_mfma_f32_16x16x32_bf16 v[52:55], a[160:163], v[188:191], v[224:227]
    buffer_load_dwordx4 v[180:183], v10, s[16:19], s79 offen offset:0 sc1
    v_mfma_f32_16x16x32_bf16 v[56:59], a[164:167], v[188:191], v[228:231]
    v_mfma_f32_16x16x32_bf16 v[60:63], a[168:171], v[188:191], v[232:235]
    v_mfma_f32_16x16x32_bf16 v[64:67], a[172:175], v[188:191], v[236:239]
    s_waitcnt vmcnt(13)
    v_mfma_f32_16x16x32_bf16 v[52:55], a[176:179], v[192:195], v[52:55]
    buffer_load_dwordx4 v[184:187], v10, s[16:19], s79 offen offset:1024 sc1
    v_mfma_f32_16x16x32_bf16 v[56:59], a[180:183], v[192:195], v[56:59]
    v_mfma_f32_16x16x32_bf16 v[60:63], a[184:187], v[192:195], v[60:63]
    v_mfma_f32_16x16x32_bf16 v[64:67], a[188:191], v[192:195], v[64:67]
    s_waitcnt vmcnt(13)
    v_mfma_f32_16x16x32_bf16 v[52:55], a[192:195], v[132:135], v[52:55]
    buffer_load_dwordx4 v[188:191], v10, s[16:19], s79 offen offset:2048 sc1
    v_mfma_f32_16x16x32_bf16 v[56:59], a[196:199], v[132:135], v[56:59]
    ds_write_b64 v216, v[36:37] offset:32768
    v_mfma_f32_16x16x32_bf16 v[60:63], a[200:203], v[132:135], v[60:63]
    ds_write_b64 v216, v[38:39] offset:32776
    v_mfma_f32_16x16x32_bf16 v[64:67], a[204:207], v[132:135], v[64:67]
    s_waitcnt vmcnt(13)
    v_mfma_f32_16x16x32_bf16 v[52:55], a[208:211], v[136:139], v[52:55]
    buffer_load_dwordx4 v[192:195], v10, s[16:19], s79 offen offset:3072 sc1
    v_mfma_f32_16x16x32_bf16 v[56:59], a[212:215], v[136:139], v[56:59]
    ds_write_b64 v217, v[40:41] offset:33792
    v_mfma_f32_16x16x32_bf16 v[60:63], a[216:219], v[136:139], v[60:63]
    ds_write_b64 v217, v[42:43] offset:33800
    s_add_u32 s79, s30, 4096
    v_mfma_f32_16x16x32_bf16 v[64:67], a[220:223], v[136:139], v[64:67]
    s_waitcnt vmcnt(13)
    v_mfma_f32_16x16x32_bf16 v[52:55], a[224:227], v[140:143], v[52:55]
    buffer_load_dwordx4 v[132:135], v10, s[16:19], s79 offen offset:0 sc1
    v_mfma_f32_16x16x32_bf16 v[56:59], a[228:231], v[140:143], v[56:59]
    ds_write_b64 v218, v[44:45] offset:34816
    v_mfma_f32_16x16x32_bf16 v[60:63], a[232:235], v[140:143], v[60:63]
    ds_write_b64 v218, v[46:47] offset:34824
    v_mfma_f32_16x16x32_bf16 v[64:67], a[236:239], v[140:143], v[64:67]
    buffer_load_dword v12, v14, s[16:19], 0 offen sc1
    s_waitcnt vmcnt(14)
    v_mfma_f32_16x16x32_bf16 v[52:55], a[240:243], v[144:147], v[52:55]
    buffer_load_dwordx4 v[136:139], v10, s[16:19], s79 offen offset:1024 sc1
    v_mfma_f32_16x16x32_bf16 v[56:59], a[244:247], v[144:147], v[56:59]
    ds_write_b64 v219, v[48:49] offset:35840
    v_mfma_f32_16x16x32_bf16 v[60:63], a[248:251], v[144:147], v[60:63]
    ds_write_b64 v219, v[50:51] offset:35848
    v_mfma_f32_16x16x32_bf16 v[64:67], a[252:255], v[144:147], v[64:67]
    s_waitcnt vmcnt(14)
    v_mfma_f32_16x16x32_bf16 v[52:55], a[0:3], v[148:151], v[52:55]
    buffer_load_dwordx4 v[140:143], v10, s[16:19], s79 offen offset:2048 sc1
    v_mfma_f32_16x16x32_bf16 v[56:59], a[4:7], v[148:151], v[56:59]
    v_mfma_f32_16x16x32_bf16 v[60:63], a[8:11], v[148:151], v[60:63]
    v_mfma_f32_16x16x32_bf16 v[64:67], a[12:15], v[148:151], v[64:67]
    s_waitcnt vmcnt(14)
    v_mfma_f32_16x16x32_bf16 v[52:55], a[16:19], v[152:155], v[52:55]
    buffer_load_dwordx4 v[144:147], v10, s[16:19], s79 offen offset:3072 sc1
    v_mfma_f32_16x16x32_bf16 v[56:59], a[20:23], v[152:155], v[56:59]
    v_mfma_f32_16x16x32_bf16 v[60:63], a[24:27], v[152:155], v[60:63]
    s_add_u32 s79, s30, 8192
    v_mfma_f32_16x16x32_bf16 v[64:67], a[28:31], v[152:155], v[64:67]
    s_waitcnt vmcnt(14)
    v_mfma_f32_16x16x32_bf16 v[52:55], a[32:35], v[156:159], v[52:55]
    buffer_load_dwordx4 v[148:151], v10, s[16:19], s79 offen offset:0 sc1
    v_mfma_f32_16x16x32_bf16 v[56:59], a[36:39], v[156:159], v[56:59]
    v_mfma_f32_16x16x32_bf16 v[60:63], a[40:43], v[156:159], v[60:63]
    v_mfma_f32_16x16x32_bf16 v[64:67], a[44:47], v[156:159], v[64:67]
    s_waitcnt vmcnt(14)
    v_mfma_f32_16x16x32_bf16 v[52:55], a[48:51], v[160:163], v[52:55]
    buffer_load_dwordx4 v[152:155], v10, s[16:19], s79 offen offset:1024 sc1
    v_mfma_f32_16x16x32_bf16 v[56:59], a[52:55], v[160:163], v[56:59]
    v_mfma_f32_16x16x32_bf16 v[60:63], a[56:59], v[160:163], v[60:63]
    v_mfma_f32_16x16x32_bf16 v[64:67], a[60:63], v[160:163], v[64:67]
    s_waitcnt vmcnt(14)
    v_mfma_f32_16x16x32_bf16 v[52:55], a[64:67], v[164:167], v[52:55]
    buffer_load_dwordx4 v[156:159], v10, s[16:19], s79 offen offset:2048 sc1
    v_mfma_f32_16x16x32_bf16 v[56:59], a[68:71], v[164:167], v[56:59]
    v_mfma_f32_16x16x32_bf16 v[60:63], a[72:75], v[164:167], v[60:63]
    v_mfma_f32_16x16x32_bf16 v[64:67], a[76:79], v[164:167], v[64:67]
    s_waitcnt vmcnt(14)
    v_mfma_f32_16x16x32_bf16 v[52:55], a[80:83], v[168:171], v[52:55]
    buffer_load_dwordx4 v[160:163], v10, s[16:19], s79 offen offset:3072 sc1
    v_mfma_f32_16x16x32_bf16 v[56:59], a[84:87], v[168:171], v[56:59]
    v_mfma_f32_16x16x32_bf16 v[60:63], a[88:91], v[168:171], v[60:63]
    s_add_u32 s79, s30, 12288
    v_mfma_f32_16x16x32_bf16 v[64:67], a[92:95], v[168:171], v[64:67]
    s_waitcnt vmcnt(14)
    v_mfma_f32_16x16x32_bf16 v[52:55], a[96:99], v[172:175], v[52:55]
    buffer_load_dwordx4 v[164:167], v11, s[16:19], s79 offen offset:0 sc1
    v_mfma_f32_16x16x32_bf16 v[56:59], a[100:103], v[172:175], v[56:59]
    v_mfma_f32_16x16x32_bf16 v[60:63], a[104:107], v[172:175], v[60:63]
    v_mfma_f32_16x16x32_bf16 v[64:67], a[108:111], v[172:175], v[64:67]
    s_waitcnt vmcnt(14)
    v_mfma_f32_16x16x32_bf16 v[52:55], a[112:115], v[176:179], v[52:55]
    buffer_load_dwordx4 v[168:171], v11, s[16:19], s79 offen offset:1024 sc1
    v_mfma_f32_16x16x32_bf16 v[56:59], a[116:119], v[176:179], v[56:59]
    v_mfma_f32_16x16x32_bf16 v[60:63], a[120:123], v[176:179], v[60:63]
    v_mfma_f32_16x16x32_bf16 v[64:67], a[124:127], v[176:179], v[64:67]
    s_waitcnt vmcnt(14)
    v_mfma_f32_16x16x32_bf16 v[36:39], a[160:163], v[180:183], v[224:227]
    s_waitcnt vmcnt(9)
    v_cmp_ne_u32 s[90:91], s60, v12
    s_nop 0
    s_cmp_eq_u64 s[90:91], 0
    s_cbranch_scc0 L_f1_slow
L_f1_done:
    s_add_u32 s79, s31, 0
    buffer_load_dwordx4 v[172:175], v10, s[16:19], s79 offen offset:0 sc1
    v_mfma_f32_16x16x32_bf16 v[40:43], a[164:167], v[180:183], v[228:231]
    v_mfma_f32_16x16x32_bf16 v[44:47], a[168:171], v[180:183], v[232:235]
    v_mfma_f32_16x16x32_bf16 v[48:51], a[172:175], v[180:183], v[236:239]
    v_mfma_f32_16x16x32_bf16 v[36:39], a[176:179], v[184:187], v[36:39]
    buffer_load_dwordx4 v[176:179], v10, s[16:19], s79 offen offset:1024 sc1
    v_mfma_f32_16x16x32_bf16 v[40:43], a[180:183], v[184:187], v[40:43]
    v_mfma_f32_16x16x32_bf16 v[44:47], a[184:187], v[184:187], v[44:47]
    v_mfma_f32_16x16x32_bf16 v[48:51], a[188:191], v[184:187], v[48:51]
    v_mfma_f32_16x16x32_bf16 v[36:39], a[192:195], v[188:191], v[36:39]
    buffer_load_dwordx4 v[180:183], v10, s[16:19], s79 offen offset:2048 sc1
    v_mfma_f32_16x16x32_bf16 v[40:43], a[196:199], v[188:191], v[40:43]
    ds_write_b64 v216, v[52:53] offset:49152
    v_mfma_f32_16x16x32_bf16 v[44:47], a[200:203], v[188:191], v[44:47]
    ds_write_b64 v216, v[54:55] offset:49160
    v_mfma_f32_16x16x32_bf16 v[48:51], a[204:207], v[188:191], v[48:51]
    v_mfma_f32_16x16x32_bf16 v[36:39], a[208:211], v[192:195], v[36:39]
    buffer_load_dwordx4 v[184:187], v10, s[16:19], s79 offen offset:3072 sc1
    v_mfma_f32_16x16x32_bf16 v[40:43], a[212:215], v[192:195], v[40:43]
    ds_write_b64 v217, v[56:57] offset:50176
    v_mfma_f32_16x16x32_bf16 v[44:47], a[216:219], v[192:195], v[44:47]
    ds_write_b64 v217, v[58:59] offset:50184
    s_add_u32 s79, s31, 4096
    v_mfma_f32_16x16x32_bf16 v[48:51], a[220:223], v[192:195], v[48:51]
    v_mfma_f32_16x16x32_bf16 v[36:39], a[224:227], v[132:135], v[36:39]
    buffer_load_dwordx4 v[188:191], v10, s[16:19], s79 offen offset:0 sc1
    v_mfma_f32_16x16x32_bf16 v[40:43], a[228:231], v[132:135], v[40:43]
    ds_write_b64 v218, v[60:61] offset:51200
    v_mfma_f32_16x16x32_bf16 v[44:47], a[232:235], v[132:135], v[44:47]
    ds_write_b64 v218, v[62:63] offset:51208
    v_mfma_f32_16x16x32_bf16 v[48:51], a[236:239], v[132:135], v[48:51]
    s_waitcnt vmcnt(13)
    v_mfma_f32_16x16x32_bf16 v[36:39], a[240:243], v[136:139], v[36:39]
    buffer_load_dwordx4 v[192:195], v10, s[16:19], s79 offen offset:1024 sc1
    v_mfma_f32_16x16x32_bf16 v[40:43], a[244:247], v[136:139], v[40:43]
    ds_write_b64 v219, v[64:65] offset:52224
    v_mfma_f32_16x16x32_bf16 v[44:47], a[248:251], v[136:139], v[44:47]
    s_waitcnt lgkmcnt(8)
    ds_write_b64 v219, v[66:67] offset:52232
    v_mfma_f32_16x16x32_bf16 v[48:51], a[252:255], v[136:139], v[48:51]
    s_waitcnt vmcnt(13)
    v_mfma_f32_16x16x32_bf16 v[36:39], a[0:3], v[140:143], v[36:39]
    buffer_load_dwordx4 v[132:135], v10, s[16:19], s79 offen offset:2048 sc1
    v_mfma_f32_16x16x32_bf16 v[40:43], a[4:7], v[140:143], v[40:43]
    v_mfma_f32_16x16x32_bf16 v[44:47], a[8:11], v[140:143], v[44:47]
    v_mfma_f32_16x16x32_bf16 v[48:51], a[12:15], v[140:143], v[48:51]
    s_waitcnt vmcnt(13)
    s_waitcnt lgkmcnt(0)
    s_barrier
    v_mfma_f32_16x16x32_bf16 v[36:39], a[16:19], v[144:147], v[36:39]
    buffer_load_dwordx4 v[136:139], v10, s[16:19], s79 offen offset:3072 sc1
    v_mfma_f32_16x16x32_bf16 v[40:43], a[20:23], v[144:147], v[40:43]
    ds_read_b128 v[68:71], v220 offset:32768
    ds_read_b128 v[72:75], v220 offset:36864
    v_mfma_f32_16x16x32_bf16 v[44:47], a[24:27], v[144:147], v[44:47]
    ds_read_b128 v[76:79], v220 offset:40960
    ds_read_b128 v[80:83], v220 offset:45056
    s_add_u32 s79, s31, 8192
    v_mfma_f32_16x16x32_bf16 v[48:51], a[28:31], v[144:147], v[48:51]
    s_waitcnt vmcnt(13)
    v_mfma_f32_16x16x32_bf16 v[36:39], a[32:35], v[148:151], v[36:39]
    buffer_load_dwordx4 v[140:143], v10, s[16:19], s79 offen offset:0 sc1
    v_mfma_f32_16x16x32_bf16 v[40:43], a[36:39], v[148:151], v[40:43]
    ds_read_b128 v[84:87], v220 offset:49152
    ds_read_b128 v[88:91], v220 offset:53248
    v_mfma_f32_16x16x32_bf16 v[44:47], a[40:43], v[148:151], v[44:47]
    ds_read_b128 v[92:95], v220 offset:57344
    ds_read_b128 v[96:99], v220 offset:61440
    v_mfma_f32_16x16x32_bf16 v[48:51], a[44:47], v[148:151], v[48:51]
    s_waitcnt vmcnt(13)
    v_mfma_f32_16x16x32_bf16 v[36:39], a[48:51], v[152:155], v[36:39]
    buffer_load_dwordx4 v[144:147], v10, s[16:19], s79 offen offset:1024 sc1
    v_mfma_f32_16x16x32_bf16 v[40:43], a[52:55], v[152:155], v[40:43]
    v_mfma_f32_16x16x32_bf16 v[44:47], a[56:59], v[152:155], v[44:47]
    v_mfma_f32_16x16x32_bf16 v[48:51], a[60:63], v[152:155], v[48:51]
    s_waitcnt vmcnt(13)
    v_mfma_f32_16x16x32_bf16 v[36:39], a[64:67], v[156:159], v[36:39]
    buffer_load_dwordx4 v[148:151], v10, s[16:19], s79 offen offset:2048 sc1
    v_mfma_f32_16x16x32_bf16 v[40:43], a[68:71], v[156:159], v[40:43]
    s_waitcnt lgkmcnt(4)
    v_add_f32_e32 v68, v68, v72
    v_mfma_f32_16x16x32_bf16 v[44:47], a[72:75], v[156:159], v[44:47]
    v_add_f32_e32 v76, v76, v80
    v_add_f32_e32 v69, v69, v73
    v_mfma_f32_16x16x32_bf16 v[48:51], a[76:79], v[156:159], v[48:51]
    s_waitcnt vmcnt(13)
    v_mfma_f32_16x16x32_bf16 v[36:39], a[80:83], v[160:163], v[36:39]
    buffer_load_dwordx4 v[152:155], v10, s[16:19], s79 offen offset:3072 sc1
    v_mfma_f32_16x16x32_bf16 v[40:43], a[84:87], v[160:163], v[40:43]
    v_add_f32_e32 v77, v77, v81
    v_add_f32_e32 v70, v70, v74
    v_mfma_f32_16x16x32_bf16 v[44:47], a[88:91], v[160:163], v[44:47]
    v_add_f32_e32 v78, v78, v82
    v_add_f32_e32 v71, v71, v75
    s_add_u32 s79, s31, 12288
    v_mfma_f32_16x16x32_bf16 v[48:51], a[92:95], v[160:163], v[48:51]
    s_waitcnt vmcnt(13)
    v_mfma_f32_16x16x32_bf16 v[36:39], a[96:99], v[164:167], v[36:39]
    buffer_load_dwordx4 v[156:159], v11, s[16:19], s79 offen offset:0 sc1
    v_mfma_f32_16x16x32_bf16 v[40:43], a[100:103], v[164:167], v[40:43]
    v_add_f32_e32 v79, v79, v83
    v_add_f32_e32 v68, v68, v76
    v_mfma_f32_16x16x32_bf16 v[44:47], a[104:107], v[164:167], v[44:47]
    v_add_f32_e32 v69, v69, v77
    v_add_f32_e32 v70, v70, v78
    v_mfma_f32_16x16x32_bf16 v[48:51], a[108:111], v[164:167], v[48:51]
    s_waitcnt vmcnt(13)
    v_mfma_f32_16x16x32_bf16 v[36:39], a[112:115], v[168:171], v[36:39]
    buffer_load_dwordx4 v[160:163], v11, s[16:19], s79 offen offset:1024 sc1
    v_mfma_f32_16x16x32_bf16 v[40:43], a[116:119], v[168:171], v[40:43]
    v_add_f32_e32 v71, v71, v79
    v_cvt_pk_bf16_f32 v100, v68, v69
    v_mfma_f32_16x16x32_bf16 v[44:47], a[120:123], v[168:171], v[44:47]
    v_cvt_pk_bf16_f32 v101, v70, v71
    buffer_store_dwordx2 v[100:101], v221, s[20:23], s34 offen sc1 nt
    s_add_u32 s79, s32, 0
    v_mfma_f32_16x16x32_bf16 v[48:51], a[124:127], v[168:171], v[48:51]
    s_waitcnt vmcnt(14)
    v_mfma_f32_16x16x32_bf16 v[52:55], a[160:163], v[172:175], v[224:227]
    buffer_load_dwordx4 v[164:167], v10, s[16:19], s79 offen offset:0 sc1
    v_mfma_f32_16x16x32_bf16 v[56:59], a[164:167], v[172:175], v[228:231]
    s_waitcnt lgkmcnt(0)
    v_add_f32_e32 v84, v84, v88
    v_mfma_f32_16x16x32_bf16 v[60:63], a[168:171], v[172:175], v[232:235]
    v_add_f32_e32 v92, v92, v96
    v_add_f32_e32 v85, v85, v89
    v_mfma_f32_16x16x32_bf16 v[64:67], a[172:175], v[172:175], v[236:239]
    s_waitcnt vmcnt(14)
    v_mfma_f32_16x16x32_bf16 v[52:55], a[176:179], v[176:179], v[52:55]
    buffer_load_dwordx4 v[168:171], v10, s[16:19], s79 offen offset:1024 sc1
    v_mfma_f32_16x16x32_bf16 v[56:59], a[180:183], v[176:179], v[56:59]
    v_add_f32_e32 v93, v93, v97
    v_add_f32_e32 v86, v86, v90
    v_mfma_f32_16x16x32_bf16 v[60:63], a[184:187], v[176:179], v[60:63]
    v_add_f32_e32 v94, v94, v98
    v_add_f32_e32 v87, v87, v91
    v_mfma_f32_16x16x32_bf16 v[64:67], a[188:191], v[176:179], v[64:67]
    s_waitcnt vmcnt(14)
    v_mfma_f32_16x16x32_bf16 v[52:55], a[192:195], v[180:183], v[52:55]
    buffer_load_dwordx4 v[172:175], v10, s[16:19], s79 offen offset:2048 sc1
    v_mfma_f32_16x16x32_bf16 v[56:59], a[196:199], v[180:183], v[56:59]
    v_add_f32_e32 v95, v95, v99
    v_add_f32_e32 v84, v84, v92
    v_mfma_f32_16x16x32_bf16 v[60:63], a[200:203], v[180:183], v[60:63]
    v_add_f32_e32 v85, v85, v93
    v_add_f32_e32 v86, v86, v94
    v_mfma_f32_16x16x32_bf16 v[64:67], a[204:207], v[180:183], v[64:67]
    s_waitcnt vmcnt(14)
    v_mfma_f32_16x16x32_bf16 v[52:55], a[208:211], v[184:187], v[52:55]
    buffer_load_dwordx4 v[176:179], v10, s[16:19], s79 offen offset:3072 sc1
    v_mfma_f32_16x16x32_bf16 v[56:59], a[212:215], v[184:187], v[56:59]
    v_add_f32_e32 v87, v87, v95
    v_cvt_pk_bf16_f32 v102, v84, v85
    v_mfma_f32_16x16x32_bf16 v[60:63], a[216:219], v[184:187], v[60:63]
    v_cvt_pk_bf16_f32 v103, v86, v87
    buffer_store_dwordx2 v[102:103], v221, s[20:23], s35 offen sc1 nt
    s_add_u32 s79, s32, 4096
    v_mfma_f32_16x16x32_bf16 v[64:67], a[220:223], v[184:187], v[64:67]
    s_waitcnt vmcnt(15)
    v_mfma_f32_16x16x32_bf16 v[52:55], a[224:227], v[188:191], v[52:55]
    buffer_load_dwordx4 v[180:183], v10, s[16:19], s79 offen offset:0 sc1
    v_mfma_f32_16x16x32_bf16 v[56:59], a[228:231], v[188:191], v[56:59]
    ds_write_b64 v216, v[36:37] offset:0
    v_mfma_f32_16x16x32_bf16 v[60:63], a[232:235], v[188:191], v[60:63]
    ds_write_b64 v216, v[38:39] offset:8
    v_mfma_f32_16x16x32_bf16 v[64:67], a[236:239], v[188:191], v[64:67]
    s_waitcnt vmcnt(15)
    v_mfma_f32_16x16x32_bf16 v[52:55], a[240:243], v[192:195], v[52:55]
    buffer_load_dwordx4 v[184:187], v10, s[16:19], s79 offen offset:1024 sc1
    v_mfma_f32_16x16x32_bf16 v[56:59], a[244:247], v[192:195], v[56:59]
    ds_write_b64 v217, v[40:41] offset:1024
    v_mfma_f32_16x16x32_bf16 v[60:63], a[248:251], v[192:195], v[60:63]
    ds_write_b64 v217, v[42:43] offset:1032
    v_mfma_f32_16x16x32_bf16 v[64:67], a[252:255], v[192:195], v[64:67]
    s_waitcnt vmcnt(15)
    v_mfma_f32_16x16x32_bf16 v[52:55], a[0:3], v[132:135], v[52:55]
    buffer_load_dwordx4 v[188:191], v10, s[16:19], s79 offen offset:2048 sc1
    v_mfma_f32_16x16x32_bf16 v[56:59], a[4:7], v[132:135], v[56:59]
    ds_write_b64 v218, v[44:45] offset:2048
    v_mfma_f32_16x16x32_bf16 v[60:63], a[8:11], v[132:135], v[60:63]
    ds_write_b64 v218, v[46:47] offset:2056
    v_mfma_f32_16x16x32_bf16 v[64:67], a[12:15], v[132:135], v[64:67]
    s_waitcnt vmcnt(15)
    v_mfma_f32_16x16x32_bf16 v[52:55], a[16:19], v[136:139], v[52:55]
    buffer_load_dwordx4 v[192:195], v10, s[16:19], s79 offen offset:3072 sc1
    v_mfma_f32_16x16x32_bf16 v[56:59], a[20:23], v[136:139], v[56:59]
    ds_write_b64 v219, v[48:49] offset:3072
    v_mfma_f32_16x16x32_bf16 v[60:63], a[24:27], v[136:139], v[60:63]
    ds_write_b64 v219, v[50:51] offset:3080
    s_add_u32 s79, s32, 8192
    v_mfma_f32_16x16x32_bf16 v[64:67], a[28:31], v[136:139], v[64:67]
    s_waitcnt vmcnt(15)
    v_mfma_f32_16x16x32_bf16 v[52:55], a[32:35], v[140:143], v[52:55]
    buffer_load_dwordx4 v[132:135], v10, s[16:19], s79 offen offset:0 sc1
    v_mfma_f32_16x16x32_bf16 v[56:59], a[36:39], v[140:143], v[56:59]
    v_mfma_f32_16x16x32_bf16 v[60:63], a[40:43], v[140:143], v[60:63]
    v_mfma_f32_16x16x32_bf16 v[64:67], a[44:47], v[140:143], v[64:67]
    s_waitcnt vmcnt(15)
    v_mfma_f32_16x16x32_bf16 v[52:55], a[48:51], v[144:147], v[52:55]
    buffer_load_dwordx4 v[136:139], v10, s[16:19], s79 offen offset:1024 sc1
    v_mfma_f32_16x16x32_bf16 v[56:59], a[52:55], v[144:147], v[56:59]
    v_mfma_f32_16x16x32_bf16 v[60:63], a[56:59], v[144:147], v[60:63]
    v_mfma_f32_16x16x32_bf16 v[64:67], a[60:63], v[144:147], v[64:67]
    s_waitcnt vmcnt(15)
    v_mfma_f32_16x16x32_bf16 v[52:55], a[64:67], v[148:151], v[52:55]
    buffer_load_dwordx4 v[140:143], v10, s[16:19], s79 offen offset:2048 sc1
    v_mfma_f32_16x16x32_bf16 v[56:59], a[68:71], v[148:151], v[56:59]
    v_mfma_f32_16x16x32_bf16 v[60:63], a[72:75], v[148:151], v[60:63]
    v_mfma_f32_16x16x32_bf16 v[64:67], a[76:79], v[148:151], v[64:67]
    s_waitcnt vmcnt(15)
    v_mfma_f32_16x16x32_bf16 v[52:55], a[80:83], v[152:155], v[52:55]
    buffer_load_dwordx4 v[144:147], v10, s[16:19], s79 offen offset:3072 sc1
    v_mfma_f32_16x16x32_bf16 v[56:59], a[84:87], v[152:155], v[56:59]
    v_mfma_f32_16x16x32_bf16 v[60:63], a[88:91], v[152:155], v[60:63]
    s_add_u32 s79, s32, 12288
    v_mfma_f32_16x16x32_bf16 v[64:67], a[92:95], v[152:155], v[64:67]
    s_waitcnt vmcnt(15)
    v_mfma_f32_16x16x32_bf16 v[52:55], a[96:99], v[156:159], v[52:55]
    buffer_load_dwordx4 v[148:151], v11, s[16:19], s79 offen offset:0 sc1
    v_mfma_f32_16x16x32_bf16 v[56:59], a[100:103], v[156:159], v[56:59]
    v_mfma_f32_16x16x32_bf16 v[60:63], a[104:107], v[156:159], v[60:63]
    v_mfma_f32_16x16x32_bf16 v[64:67], a[108:111], v[156:159], v[64:67]
    s_waitcnt vmcnt(15)
    v_mfma_f32_16x16x32_bf16 v[52:55], a[112:115], v[160:163], v[52:55]
    buffer_load_dwordx4 v[152:155], v11, s[16:19], s79 offen offset:1024 sc1
L_pg1_0:
    s_cbranch_execz L_pg1_1
    s_nop 0
    v_mfma_f32_16x16x32_bf16 v[56:59], a[116:119], v[160:163], v[56:59]
    v_mfma_f32_16x16x32_bf16 v[60:63], a[120:123], v[160:163], v[60:63]
    s_add_u32 s79, s33, 0
    v_mfma_f32_16x16x32_bf16 v[64:67], a[124:127], v[160:163], v[64:67]
    s_waitcnt vmcnt(14)
    v_mfma_f32_16x16x32_bf16 v[36:39], a[160:163], v[164:167], v[224:227]
    buffer_load_dwordx4 v[156:159], v10, s[16:19], s79 offen offset:0 sc1
    v_mfma_f32_16x16x32_bf16 v[40:43], a[164:167], v[164:167], v[228:231]
    v_mfma_f32_16x16x32_bf16 v[44:47], a[168:171], v[164:167], v[232:235]
    v_mfma_f32_16x16x32_bf16 v[48:51], a[172:175], v[164:167], v[236:239]
    s_waitcnt vmcnt(14)
    v_mfma_f32_16x16x32_bf16 v[36:39], a[176:179], v[168:171], v[36:39]
    buffer_load_dwordx4 v[160:163], v10, s[16:19], s79 offen offset:1024 sc1
    v_mfma_f32_16x16x32_bf16 v[40:43], a[180:183], v[168:171], v[40:43]
    v_mfma_f32_16x16x32_bf16 v[44:47], a[184:187], v[168:171], v[44:47]
    v_mfma_f32_16x16x32_bf16 v[48:51], a[188:191], v[168:171], v[48:51]
    s_waitcnt vmcnt(14)
    v_mfma_f32_16x16x32_bf16 v[36:39], a[192:195], v[172:175], v[36:39]
    buffer_load_dwordx4 v[164:167], v10, s[16:19], s79 offen offset:2048 sc1
    v_mfma_f32_16x16x32_bf16 v[40:43], a[196:199], v[172:175], v[40:43]
    ds_write_b64 v216, v[52:53] offset:16384
    v_mfma_f32_16x16x32_bf16 v[44:47], a[200:203], v[172:175], v[44:47]
    ds_write_b64 v216, v[54:55] offset:16392
    v_mfma_f32_16x16x32_bf16 v[48:51], a[204:207], v[172:175], v[48:51]
    s_waitcnt vmcnt(14)
    v_mfma_f32_16x16x32_bf16 v[36:39], a[208:211], v[176:179], v[36:39]
    buffer_load_dwordx4 v[168:171], v10, s[16:19], s79 offen offset:3072 sc1
    v_mfma_f32_16x16x32_bf16 v[40:43], a[212:215], v[176:179], v[40:43]
    ds_write_b64 v217, v[56:57] offset:17408
    v_mfma_f32_16x16x32_bf16 v[44:47], a[216:219], v[176:179], v[44:47]
    ds_write_b64 v217, v[58:59] offset:17416
    s_add_u32 s79, s33, 4096
    v_mfma_f32_16x16x32_bf16 v[48:51], a[220:223], v[176:179], v[48:51]
    s_waitcnt vmcnt(13)
    v_mfma_f32_16x16x32_bf16 v[36:39], a[224:227], v[180:183], v[36:39]
    buffer_load_dwordx4 v[172:175], v10, s[16:19], s79 offen offset:0 sc1
    v_mfma_f32_16x16x32_bf16 v[40:43], a[228:231], v[180:183], v[40:43]
    ds_write_b64 v218, v[60:61] offset:18432
    v_mfma_f32_16x16x32_bf16 v[44:47], a[232:235], v[180:183], v[44:47]
    ds_write_b64 v218, v[62:63] offset:18440
    v_mfma_f32_16x16x32_bf16 v[48:51], a[236:239], v[180:183], v[48:51]
    s_waitcnt vmcnt(13)
    v_mfma_f32_16x16x32_bf16 v[36:39], a[240:243], v[184:187], v[36:39]
    buffer_load_dwordx4 v[176:179], v10, s[16:19], s79 offen offset:1024 sc1
    v_mfma_f32_16x16x32_bf16 v[40:43], a[244:247], v[184:187], v[40:43]
    ds_write_b64 v219, v[64:65] offset:19456
    v_mfma_f32_16x16x32_bf16 v[44:47], a[248:251], v[184:187], v[44:47]
    s_waitcnt lgkmcnt(8)
    ds_write_b64 v219, v[66:67] offset:19464
    v_mfma_f32_16x16x32_bf16 v[48:51], a[252:255], v[184:187], v[48:51]
    s_waitcnt vmcnt(13)
    v_mfma_f32_16x16x32_bf16 v[36:39], a[0:3], v[188:191], v[36:39]
    buffer_load_dwordx4 v[180:183], v10, s[16:19], s79 offen offset:2048 sc1
    v_mfma_f32_16x16x32_bf16 v[40:43], a[4:7], v[188:191], v[40:43]
    v_mfma_f32_16x16x32_bf16 v[44:47], a[8:11], v[188:191], v[44:47]
    v_mfma_f32_16x16x32_bf16 v[48:51], a[12:15], v[188:191], v[48:51]
    s_waitcnt vmcnt(13)
    s_waitcnt lgkmcnt(0)
    s_barrier
    v_mfma_f32_16x16x32_bf16 v[36:39], a[16:19], v[192:195], v[36:39]
    buffer_load_dwordx4 v[184:187], v10, s[16:19], s79 offen offset:3072 sc1
    v_mfma_f32_16x16x32_bf16 v[40:43], a[20:23], v[192:195], v[40:43]
    ds_read_b128 v[68:71], v220 offset:0
    ds_read_b128 v[72:75], v220 offset:4096
    v_mfma_f32_16x16x32_bf16 v[44:47], a[24:27], v[192:195], v[44:47]
    ds_read_b128 v[76:79], v220 offset:8192
    ds_read_b128 v[80:83], v220 offset:12288
    s_add_u32 s79, s33, 8192
    v_mfma_f32_16x16x32_bf16 v[48:51], a[28:31], v[192:195], v[48:51]
    s_waitcnt vmcnt(13)
    v_mfma_f32_16x16x32_bf16 v[36:39], a[32:35], v[132:135], v[36:39]
    buffer_load_dwordx4 v[188:191], v10, s[16:19], s79 offen offset:0 sc1
    v_mfma_f32_16x16x32_bf16 v[40:43], a[36:39], v[132:135], v[40:43]
    ds_read_b128 v[84:87], v220 offset:16384
    ds_read_b128 v[88:91], v220 offset:20480
    v_mfma_f32_16x16x32_bf16 v[44:47], a[40:43], v[132:135], v[44:47]
    ds_read_b128 v[92:95], v220 offset:24576
    ds_read_b128 v[96:99], v220 offset:28672
    v_mfma_f32_16x16x32_bf16 v[48:51], a[44:47], v[132:135], v[48:51]
    s_waitcnt vmcnt(13)
    v_mfma_f32_16x16x32_bf16 v[36:39], a[48:51], v[136:139], v[36:39]
    buffer_load_dwordx4 v[192:195], v10, s[16:19], s79 offen offset:1024 sc1
    v_mfma_f32_16x16x32_bf16 v[40:43], a[52:55], v[136:139], v[40:43]
    v_mfma_f32_16x16x32_bf16 v[44:47], a[56:59], v[136:139], v[44:47]
    v_mfma_f32_16x16x32_bf16 v[48:51], a[60:63], v[136:139], v[48:51]
    s_waitcnt vmcnt(13)
    v_mfma_f32_16x16x32_bf16 v[36:39], a[64:67], v[140:143], v[36:39]
    buffer_load_dwordx4 v[132:135], v10, s[16:19], s79 offen offset:2048 sc1
    v_mfma_f32_16x16x32_bf16 v[40:43], a[68:71], v[140:143], v[40:43]
    s_waitcnt lgkmcnt(4)
    v_add_f32_e32 v68, v68, v72
    v_mfma_f32_16x16x32_bf16 v[44:47], a[72:75], v[140:143], v[44:47]
    v_add_f32_e32 v76, v76, v80
    v_add_f32_e32 v69, v69, v73
    v_mfma_f32_16x16x32_bf16 v[48:51], a[76:79], v[140:143], v[48:51]
    s_waitcnt vmcnt(13)
    v_mfma_f32_16x16x32_bf16 v[36:39], a[80:83], v[144:147], v[36:39]
    buffer_load_dwordx4 v[136:139], v10, s[16:19], s79 offen offset:3072 sc1
    v_mfma_f32_16x16x32_bf16 v[40:43], a[84:87], v[144:147], v[40:43]
    v_add_f32_e32 v77, v77, v81
    v_add_f32_e32 v70, v70, v74
    v_mfma_f32_16x16x32_bf16 v[44:47], a[88:91], v[144:147], v[44:47]
    v_add_f32_e32 v78, v78, v82
    v_add_f32_e32 v71, v71, v75
    s_add_u32 s79, s33, 12288
    v_mfma_f32_16x16x32_bf16 v[48:51], a[92:95], v[144:147], v[48:51]
    s_waitcnt vmcnt(13)
    v_mfma_f32_16x16x32_bf16 v[36:39], a[96:99], v[148:151], v[36:39]
    buffer_load_dwordx4 v[140:143], v11, s[16:19], s79 offen offset:0 sc1
    v_mfma_f32_16x16x32_bf16 v[40:43], a[100:103], v[148:151], v[40:43]
    v_add_f32_e32 v79, v79, v83
    v_add_f32_e32 v68, v68, v76
    v_mfma_f32_16x16x32_bf16 v[44:47], a[104:107], v[148:151], v[44:47]
    v_add_f32_e32 v69, v69, v77
    v_add_f32_e32 v70, v70, v78
    v_mfma_f32_16x16x32_bf16 v[48:51], a[108:111], v[148:151], v[48:51]
    s_waitcnt vmcnt(13)
    v_mfma_f32_16x16x32_bf16 v[36:39], a[112:115], v[152:155], v[36:39]
    buffer_load_dwordx4 v[144:147], v11, s[16:19], s79 offen offset:1024 sc1
    v_add_f32_e32 v71, v71, v79
    v_cvt_pk_bf16_f32 v104, v68, v69
    v_mfma_f32_16x16x32_bf16 v[40:43], a[116:119], v[152:155], v[40:43]
    v_cvt_pk_bf16_f32 v105, v70, v71
    buffer_store_dwordx2 v[104:105], v221, s[20:23], s94 offen sc1 nt
    v_mfma_f32_16x16x32_bf16 v[44:47], a[120:123], v[152:155], v[44:47]
    s_waitcnt lgkmcnt(0)
    v_add_f32_e32 v84, v84, v88
    v_mfma_f32_16x16x32_bf16 v[48:51], a[124:127], v[152:155], v[48:51]
    s_waitcnt vmcnt(14)
    v_mfma_f32_16x16x32_bf16 v[52:55], a[160:163], v[156:159], v[224:227]
    v_add_f32_e32 v92, v92, v96
    v_add_f32_e32 v85, v85, v89
    v_mfma_f32_16x16x32_bf16 v[56:59], a[164:167], v[156:159], v[228:231]
    v_add_f32_e32 v93, v93, v97
    v_add_f32_e32 v86, v86, v90
    v_mfma_f32_16x16x32_bf16 v[60:63], a[168:171], v[156:159], v[232:235]
    v_add_f32_e32 v94, v94, v98
    v_add_f32_e32 v87, v87, v91
    v_mfma_f32_16x16x32_bf16 v[64:67], a[172:175], v[156:159], v[236:239]
    s_waitcnt vmcnt(13)
    v_mfma_f32_16x16x32_bf16 v[52:55], a[176:179], v[160:163], v[52:55]
    v_add_f32_e32 v95, v95, v99
    v_add_f32_e32 v84, v84, v92
    v_mfma_f32_16x16x32_bf16 v[56:59], a[180:183], v[160:163], v[56:59]
    v_add_f32_e32 v85, v85, v93
    v_add_f32_e32 v86, v86, v94
    v_mfma_f32_16x16x32_bf16 v[60:63], a[184:187], v[160:163], v[60:63]
    v_add_f32_e32 v87, v87, v95
    v_cvt_pk_bf16_f32 v106, v84, v85
    v_mfma_f32_16x16x32_bf16 v[64:67], a[188:191], v[160:163], v[64:67]
    s_waitcnt vmcnt(12)
    v_mfma_f32_16x16x32_bf16 v[52:55], a[192:195], v[164:167], v[52:55]
    v_cvt_pk_bf16_f32 v107, v86, v87
    buffer_store_dwordx2 v[106:107], v221, s[20:23], s95 offen sc1 nt
    v_mfma_f32_16x16x32_bf16 v[56:59], a[196:199], v[164:167], v[56:59]
    ds_write_b64 v216, v[36:37] offset:32768
    v_mfma_f32_16x16x32_bf16 v[60:63], a[200:203], v[164:167], v[60:63]
    ds_write_b64 v216, v[38:39] offset:32776
    v_mfma_f32_16x16x32_bf16 v[64:67], a[204:207], v[164:167], v[64:67]
    s_waitcnt vmcnt(12)
    v_mfma_f32_16x16x32_bf16 v[52:55], a[208:211], v[168:171], v[52:55]
    ds_write_b64 v217, v[40:41] offset:33792
    v_mfma_f32_16x16x32_bf16 v[56:59], a[212:215], v[168:171], v[56:59]
    ds_write_b64 v217, v[42:43] offset:33800
    v_mfma_f32_16x16x32_bf16 v[60:63], a[216:219], v[168:171], v[60:63]
    ds_write_b64 v218, v[44:45] offset:34816
    v_mfma_f32_16x16x32_bf16 v[64:67], a[220:223], v[168:171], v[64:67]
    s_waitcnt vmcnt(11)
    v_mfma_f32_16x16x32_bf16 v[52:55], a[224:227], v[172:175], v[52:55]
    ds_write_b64 v218, v[46:47] offset:34824
    v_mfma_f32_16x16x32_bf16 v[56:59], a[228:231], v[172:175], v[56:59]
    ds_write_b64 v219, v[48:49] offset:35840
    v_mfma_f32_16x16x32_bf16 v[60:63], a[232:235], v[172:175], v[60:63]
    ds_write_b64 v219, v[50:51] offset:35848
    v_mfma_f32_16x16x32_bf16 v[64:67], a[236:239], v[172:175], v[64:67]
    s_waitcnt vmcnt(10)
    v_mfma_f32_16x16x32_bf16 v[52:55], a[240:243], v[176:179], v[52:55]
    v_mfma_f32_16x16x32_bf16 v[56:59], a[244:247], v[176:179], v[56:59]
    v_mfma_f32_16x16x32_bf16 v[60:63], a[248:251], v[176:179], v[60:63]
    v_mfma_f32_16x16x32_bf16 v[64:67], a[252:255], v[176:179], v[64:67]
    s_waitcnt vmcnt(9)
    v_mfma_f32_16x16x32_bf16 v[52:55], a[0:3], v[180:183], v[52:55]
    v_mfma_f32_16x16x32_bf16 v[56:59], a[4:7], v[180:183], v[56:59]
    v_mfma_f32_16x16x32_bf16 v[60:63], a[8:11], v[180:183], v[60:63]
    v_mfma_f32_16x16x32_bf16 v[64:67], a[12:15], v[180:183], v[64:67]
    s_waitcnt vmcnt(8)
    s_waitcnt lgkmcnt(0)
    s_barrier
    v_mfma_f32_16x16x32_bf16 v[52:55], a[16:19], v[184:187], v[52:55]
    ds_read_b128 v[68:71], v220 offset:32768
    ds_read_b128 v[72:75], v220 offset:36864
    v_mfma_f32_16x16x32_bf16 v[56:59], a[20:23], v[184:187], v[56:59]
    ds_read_b128 v[76:79], v220 offset:40960
    ds_read_b128 v[80:83], v220 offset:45056
    v_mfma_f32_16x16x32_bf16 v[60:63], a[24:27], v[184:187], v[60:63]
    v_mfma_f32_16x16x32_bf16 v[64:67], a[28:31], v[184:187], v[64:67]
    s_waitcnt vmcnt(7)
    v_mfma_f32_16x16x32_bf16 v[52:55], a[32:35], v[188:191], v[52:55]
    v_mfma_f32_16x16x32_bf16 v[56:59], a[36:39], v[188:191], v[56:59]
    v_mfma_f32_16x16x32_bf16 v[60:63], a[40:43], v[188:191], v[60:63]
    v_mfma_f32_16x16x32_bf16 v[64:67], a[44:47], v[188:191], v[64:67]
    s_waitcnt vmcnt(6)
    v_mfma_f32_16x16x32_bf16 v[52:55], a[48:51], v[192:195], v[52:55]
    s_waitcnt lgkmcnt(0)
    v_add_f32_e32 v68, v68, v72
    v_mfma_f32_16x16x32_bf16 v[56:59], a[52:55], v[192:195], v[56:59]
    v_add_f32_e32 v76, v76, v80
    v_add_f32_e32 v69, v69, v73
    v_mfma_f32_16x16x32_bf16 v[60:63], a[56:59], v[192:195], v[60:63]
    v_add_f32_e32 v77, v77, v81
    v_add_f32_e32 v70, v70, v74
    v_mfma_f32_16x16x32_bf16 v[64:67], a[60:63], v[192:195], v[64:67]
    s_waitcnt vmcnt(5)
    v_mfma_f32_16x16x32_bf16 v[52:55], a[64:67], v[132:135], v[52:55]
    v_add_f32_e32 v78, v78, v82
    v_add_f32_e32 v71, v71, v75
    v_mfma_f32_16x16x32_bf16 v[56:59], a[68:71], v[132:135], v[56:59]
    v_add_f32_e32 v79, v79, v83
    v_add_f32_e32 v68, v68, v76
    v_mfma_f32_16x16x32_bf16 v[60:63], a[72:75], v[132:135], v[60:63]
    v_add_f32_e32 v69, v69, v77
    v_add_f32_e32 v70, v70, v78
    v_mfma_f32_16x16x32_bf16 v[64:67], a[76:79], v[132:135], v[64:67]
    s_waitcnt vmcnt(4)
    v_mfma_f32_16x16x32_bf16 v[52:55], a[80:83], v[136:139], v[52:55]
    v_add_f32_e32 v71, v71, v79
    v_cvt_pk_bf16_f32 v108, v68, v69
    v_mfma_f32_16x16x32_bf16 v[56:59], a[84:87], v[136:139], v[56:59]
    v_cvt_pk_bf16_f32 v109, v70, v71
    buffer_store_dwordx2 v[108:109], v221, s[20:23], s96 offen sc1 nt
    v_mfma_f32_16x16x32_bf16 v[60:63], a[88:91], v[136:139], v[60:63]
    v_mfma_f32_16x16x32_bf16 v[64:67], a[92:95], v[136:139], v[64:67]
    s_waitcnt vmcnt(4)
    v_mfma_f32_16x16x32_bf16 v[52:55], a[96:99], v[140:143], v[52:55]
    v_mfma_f32_16x16x32_bf16 v[56:59], a[100:103], v[140:143], v[56:59]
    v_mfma_f32_16x16x32_bf16 v[60:63], a[104:107], v[140:143], v[60:63]
    v_mfma_f32_16x16x32_bf16 v[64:67], a[108:111], v[140:143], v[64:67]
    s_waitcnt vmcnt(3)
    v_mfma_f32_16x16x32_bf16 v[52:55], a[112:115], v[144:147], v[52:55]
    v_mfma_f32_16x16x32_bf16 v[56:59], a[116:119], v[144:147], v[56:59]
    v_mfma_f32_16x16x32_bf16 v[60:63], a[120:123], v[144:147], v[60:63]
    v_mfma_f32_16x16x32_bf16 v[64:67], a[124:127], v[144:147], v[64:67]
    s_nop 4
    ds_write_b128 v216, v[52:55] offset:49152
    ds_write_b128 v217, v[56:59] offset:50176
    ds_write_b128 v218, v[60:63] offset:51200
    ds_write_b128 v219, v[64:67] offset:52224
    s_waitcnt lgkmcnt(0)
    s_barrier
    ds_read_b128 v[84:87], v220 offset:49152
    ds_read_b128 v[88:91], v220 offset:53248
    ds_read_b128 v[92:95], v220 offset:57344
    ds_read_b128 v[96:99], v220 offset:61440
    s_waitcnt lgkmcnt(0)
    v_pk_add_f32 v[84:85], v[84:85], v[88:89]
    v_pk_add_f32 v[92:93], v[92:93], v[96:97]
    v_pk_add_f32 v[86:87], v[86:87], v[90:91]
    v_pk_add_f32 v[94:95], v[94:95], v[98:99]
    v_pk_add_f32 v[84:85], v[84:85], v[92:93]
    v_pk_add_f32 v[86:87], v[86:87], v[94:95]
    v_cvt_pk_bf16_f32 v110, v84, v85
    v_cvt_pk_bf16_f32 v111, v86, v87
    buffer_store_dwordx2 v[110:111], v221, s[20:23], s97 offen sc1 nt
L_fin:
L_end:
    s_endpgm
L_late_tag:
    s_mov_b32 s89, 0
L_lt:
    s_cmp_lt_u32 s89, 300
    s_cbranch_scc0 L_lt_at
    buffer_load_dword v15, off, s[36:39], 0 sc1
    s_branch L_lt_ck
L_lt_at:
    v_mov_b32 v15, 0
    s_mov_b64 exec, 1
    buffer_atomic_or v15, off, s[36:39], 0 sc0 sc1
    s_mov_b64 exec, -1
L_lt_ck:
    s_waitcnt vmcnt(0)
    v_readfirstlane_b32 s60, v15
    s_add_u32 s89, s89, 1
    s_cmp_lg_u32 s60, 0
    s_cbranch_scc1 L_lt_ok
    s_sleep 4
    s_cmp_lt_u32 s89, 6000
    s_cbranch_scc1 L_lt
L_lt_ok:
    s_branch L_have_tag
L_nop2:
    s_mov_b64 exec, 0xff
    s_waitcnt vmcnt(0)
    buffer_store_dwordx4 v[32:35], v10, s[16:19], s88 offen sc1
    s_mov_b64 exec, -1
    s_branch L_fin
L_f0_slow:
    s_mov_b64 exec, 0xff
    s_waitcnt vmcnt(0)
    buffer_store_dwordx4 v[32:35], v10, s[16:19], s88 offen sc1
    s_mov_b64 exec, -1
    s_mov_b32 s89, 0
L_f0:
    s_cmp_lt_u32 s89, 300
    s_cbranch_scc0 L_f0_at
    buffer_load_dword v12, v13, s[16:19], 0 offen sc1
    s_branch L_f0_ck
L_f0_at:
    v_mov_b32 v12, 0
    buffer_atomic_or v12, v13, s[16:19], 0 offen sc0 sc1
L_f0_ck:
    s_waitcnt vmcnt(0)
    v_cmp_ne_u32 s[90:91], s60, v12
    s_add_u32 s89, s89, 1
    s_cmp_eq_u64 s[90:91], 0
    s_cbranch_scc1 L_f0_ok
    s_sleep 1
    s_cmp_lt_u32 s89, 6000
    s_cbranch_scc1 L_f0
L_f0_ok:
    s_add_u32 s79, s28, 0
    buffer_load_dwordx4 v[132:135], v10, s[16:19], s79 offen offset:0 sc1
    buffer_load_dwordx4 v[136:139], v10, s[16:19], s79 offen offset:1024 sc1
    buffer_load_dwordx4 v[140:143], v10, s[16:19], s79 offen offset:2048 sc1
    buffer_load_dwordx4 v[144:147], v10, s[16:19], s79 offen offset:3072 sc1
    s_add_u32 s79, s28, 4096
    buffer_load_dwordx4 v[148:151], v10, s[16:19], s79 offen offset:0 sc1
    buffer_load_dwordx4 v[152:155], v10, s[16:19], s79 offen offset:1024 sc1
    buffer_load_dwordx4 v[156:159], v10, s[16:19], s79 offen offset:2048 sc1
    buffer_load_dwordx4 v[160:163], v10, s[16:19], s79 offen offset:3072 sc1
    ds_read_b64_tr_b16 a[16:17], v208 offset:0
    ds_read_b64_tr_b16 a[18:19], v208 offset:2048
    ds_read_b64_tr_b16 a[20:21], v209 offset:0
    ds_read_b64_tr_b16 a[22:23], v209 offset:2048
    ds_read_b64_tr_b16 a[24:25], v210 offset:0
    ds_read_b64_tr_b16 a[26:27], v210 offset:2048
    ds_read_b64_tr_b16 a[28:29], v211 offset:0
    ds_read_b64_tr_b16 a[30:31], v211 offset:2048
    ds_read_b64_tr_b16 a[32:33], v208 offset:16384
    ds_read_b64_tr_b16 a[34:35], v208 offset:18432
    ds_read_b64_tr_b16 a[36:37], v209 offset:16384
    ds_read_b64_tr_b16 a[38:39], v209 offset:18432
    ds_read_b64_tr_b16 a[40:41], v210 offset:16384
    ds_read_b64_tr_b16 a[42:43], v210 offset:18432
    ds_read_b64_tr_b16 a[44:45], v211 offset:16384
    s_waitcnt lgkmcnt(8)
    ds_read_b64_tr_b16 a[46:47], v211 offset:18432
    ds_read_b64_tr_b16 a[48:49], v204 offset:32768
    ds_read_b64_tr_b16 a[50:51], v204 offset:34816
    ds_read_b64_tr_b16 a[52:53], v205 offset:32768
    ds_read_b64_tr_b16 a[54:55], v205 offset:34816
    ds_read_b64_tr_b16 a[56:57], v206 offset:32768
    ds_read_b64_tr_b16 a[58:59], v206 offset:34816
    s_waitcnt lgkmcnt(8)
    ds_read_b64_tr_b16 a[60:61], v207 offset:32768
    ds_read_b64_tr_b16 a[62:63], v207 offset:34816
    ds_read_b64_tr_b16 a[64:65], v204 offset:49152
    ds_read_b64_tr_b16 a[66:67], v204 offset:51200
    ds_read_b64_tr_b16 a[68:69], v205 offset:49152
    ds_read_b64_tr_b16 a[70:71], v205 offset:51200
    ds_read_b64_tr_b16 a[72:73], v206 offset:49152
    s_waitcnt lgkmcnt(8)
    ds_read_b64_tr_b16 a[74:75], v206 offset:51200
    ds_read_b64_tr_b16 a[76:77], v207 offset:49152
    ds_read_b64_tr_b16 a[78:79], v207 offset:51200
    s_branch L_rest
L_f1_slow:
    s_mov_b32 s89, 0
L_f1:
    s_cmp_lt_u32 s89, 300
    s_cbranch_scc0 L_f1_at
    buffer_load_dword v12, v14, s[16:19], 0 offen sc1
    s_branch L_f1_ck
L_f1_at:
    v_mov_b32 v12, 0
    buffer_atomic_or v12, v14, s[16:19], 0 offen sc0 sc1
L_f1_ck:
    s_waitcnt vmcnt(0)
    v_cmp_ne_u32 s[90:91], s60, v12
    s_add_u32 s89, s89, 1
    s_cmp_eq_u64 s[90:91], 0
    s_cbranch_scc1 L_f1_ok
    s_sleep 1
    s_cmp_lt_u32 s89, 6000
    s_cbranch_scc1 L_f1
L_f1_ok:
    s_branch L_f1_done
L_helper:
    s_waitcnt lgkmcnt(0)
    s_lshl_b32 s64, s2, 2
    s_add_u32 s64, s64, s3
    v_mov_b32 v2, 0
    s_cmp_eq_u32 s64, 1023
    s_cbranch_scc0 L_notpub
    global_load_dword v15, v2, s[54:55] offset:0 sc1
    s_waitcnt vmcnt(0)
    v_readfirstlane_b32 s60, v15
    s_add_u32 s60, s60, 0x9e3779b9
    s_cmp_eq_u32 s60, 0
    s_cselect_b32 s60, 0x9e3779b9, s60
    v_mov_b32 v15, s60
    s_mov_b64 exec, 1
    global_store_dword v2, v15, s[52:53] sc1
    global_store_dword v2, v15, s[54:55] offset:0 sc1
    s_mov_b64 exec, -1
L_notpub:
    s_mov_b64 s[8:9], s[40:41]
    s_mov_b32 s10, 2621440
    s_mov_b32 s11, 0x20000
    s_mov_b64 s[24:25], s[46:47]
    s_mov_b32 s26, 2211840
    s_mov_b32 s27, 0x20000
    s_mov_b64 s[16:17], s[54:55]
    s_mov_b32 s18, 16777216
    s_mov_b32 s19, 0x20000
    s_sub_u32 s64, s5, 28
    s_lshl_b32 s64, s64, 8
    v_add_u32 v3, s64, v0
    s_lshr_b32 s67, s4, 1
    s_mul_i32 s67, s67, 655360
    s_add_u32 s67, s67, 81920
    s_mov_b32 s74, 52429
    s_and_b32 s66, s4, 1
    s_mul_i32 s64, s66, 1280
    v_add_u32 v4, 0, v3
    v_cmp_gt_u32 vcc, 1280, v4
    v_add_u32 v4, s64, v4
    v_subrev_u32 v5, 2560, v4
    v_min_u32 v4, v4, v5
    v_mul_lo_u32 v5, v4, s74
    v_lshrrev_b32 v5, 25, v5
    v_mul_u32_u24 v5, 640, v5
    v_add_lshl_u32 v16, v4, v5, 7
    v_mov_b32 v5, 1073741824
    v_cndmask_b32 v16, v5, v16, vcc
    v_add_u32 v4, 1024, v3
    v_cmp_gt_u32 vcc, 1280, v4
    v_add_u32 v4, s64, v4
    v_subrev_u32 v5, 2560, v4
    v_min_u32 v4, v4, v5
    v_mul_lo_u32 v5, v4, s74
    v_lshrrev_b32 v5, 25, v5
    v_mul_u32_u24 v5, 640, v5
    v_add_lshl_u32 v17, v4, v5, 7
    v_mov_b32 v5, 1073741824
    v_cndmask_b32 v17, v5, v17, vcc
    v_add_u32 v4, 2048, v3
    v_cmp_gt_u32 vcc, 1280, v4
    v_add_u32 v4, s64, v4
    v_subrev_u32 v5, 2560, v4
    v_min_u32 v4, v4, v5
    v_mul_lo_u32 v5, v4, s74
    v_lshrrev_b32 v5, 25, v5
    v_mul_u32_u24 v5, 640, v5
    v_add_lshl_u32 v18, v4, v5, 7
    v_mov_b32 v5, 1073741824
    v_cndmask_b32 v18, v5, v18, vcc
    s_mul_i32 s66, s66, 640
    s_and_b32 s65, s4, 6
    s_mov_b32 s6, 0x34567810
    s_cmp_eq_u32 s65, 2
    s_cselect_b32 s6, 0x14567832, s6
    s_cmp_eq_u32 s65, 4
    s_cselect_b32 s6, 0x12367854, s6
    s_cmp_eq_u32 s65, 6
    s_cselect_b32 s6, 0x12345876, s6
    s_bfe_u32 s64, s6, 0x40000
    s_lshl_b32 s64, s64, 10
    v_add_u32 v4, s64, v3
    v_mul_lo_u32 v5, v4, s74
    v_lshrrev_b32 v5, 18, v5
    v_mul_u32_u24 v6, 5, v5
    v_sub_u32 v4, v4, v6
    v_bfe_u32 v6, v5, 5, 2
    v_mul_u32_u24 v6, 448, v6
    v_lshrrev_b32 v7, 7, v5
    v_lshl_add_u32 v6, v7, 5, v6
    v_and_b32 v5, 31, v5
    v_add_u32 v6, v6, v5
    v_mul_u32_u24 v6, 1280, v6
    v_cmp_gt_u32 vcc, 14, v7
    v_lshl_add_u32 v20, v4, 7, v6
    v_mov_b32 v5, 1073741824
    v_cndmask_b32 v20, v5, v20, vcc
    s_bfe_u32 s64, s6, 0x40004
    s_lshl_b32 s64, s64, 10
    v_add_u32 v4, s64, v3
    v_mul_lo_u32 v5, v4, s74
    v_lshrrev_b32 v5, 18, v5
    v_mul_u32_u24 v6, 5, v5
    v_sub_u32 v4, v4, v6
    v_bfe_u32 v6, v5, 5, 2
    v_mul_u32_u24 v6, 448, v6
    v_lshrrev_b32 v7, 7, v5
    v_lshl_add_u32 v6, v7, 5, v6
    v_and_b32 v5, 31, v5
    v_add_u32 v6, v6, v5
    v_mul_u32_u24 v6, 1280, v6
    v_cmp_gt_u32 vcc, 14, v7
    v_lshl_add_u32 v21, v4, 7, v6
    v_mov_b32 v5, 1073741824
    v_cndmask_b32 v21, v5, v21, vcc
    s_bfe_u32 s64, s6, 0x40008
    s_lshl_b32 s64, s64, 10
    v_add_u32 v4, s64, v3
    v_mul_lo_u32 v5, v4, s74
    v_lshrrev_b32 v5, 18, v5
    v_mul_u32_u24 v6, 5, v5
    v_sub_u32 v4, v4, v6
    v_bfe_u32 v6, v5, 5, 2
    v_mul_u32_u24 v6, 448, v6
    v_lshrrev_b32 v7, 7, v5
    v_lshl_add_u32 v6, v7, 5, v6
    v_and_b32 v5, 31, v5
    v_add_u32 v6, v6, v5
    v_mul_u32_u24 v6, 1280, v6
    v_cmp_gt_u32 vcc, 14, v7
    v_lshl_add_u32 v22, v4, 7, v6
    v_mov_b32 v5, 1073741824
    v_cndmask_b32 v22, v5, v22, vcc
    s_bfe_u32 s64, s6, 0x4000c
    s_lshl_b32 s64, s64, 10
    v_add_u32 v4, s64, v3
    v_mul_lo_u32 v5, v4, s74
    v_lshrrev_b32 v5, 18, v5
    v_mul_u32_u24 v6, 5, v5
    v_sub_u32 v4, v4, v6
    v_bfe_u32 v6, v5, 5, 2
    v_mul_u32_u24 v6, 448, v6
    v_lshrrev_b32 v7, 7, v5
    v_lshl_add_u32 v6, v7, 5, v6
    v_and_b32 v5, 31, v5
    v_add_u32 v6, v6, v5
    v_mul_u32_u24 v6, 1280, v6
    v_cmp_gt_u32 vcc, 14, v7
    v_lshl_add_u32 v23, v4, 7, v6
    v_mov_b32 v5, 1073741824
    v_cndmask_b32 v23, v5, v23, vcc
    s_bfe_u32 s64, s6, 0x40010
    s_lshl_b32 s64, s64, 10
    v_add_u32 v4, s64, v3
    v_mul_lo_u32 v5, v4, s74
    v_lshrrev_b32 v5, 18, v5
    v_mul_u32_u24 v6, 5, v5
    v_sub_u32 v4, v4, v6
    v_bfe_u32 v6, v5, 5, 2
    v_mul_u32_u24 v6, 448, v6
    v_lshrrev_b32 v7, 7, v5
    v_lshl_add_u32 v6, v7, 5, v6
    v_and_b32 v5, 31, v5
    v_add_u32 v6, v6, v5
    v_mul_u32_u24 v6, 1280, v6
    v_cmp_gt_u32 vcc, 14, v7
    v_lshl_add_u32 v24, v4, 7, v6
    v_mov_b32 v5, 1073741824
    v_cndmask_b32 v24, v5, v24, vcc
    s_bfe_u32 s64, s6, 0x40014
    s_lshl_b32 s64, s64, 10
    v_add_u32 v4, s64, v3
    v_mul_lo_u32 v5, v4, s74
    v_lshrrev_b32 v5, 18, v5
    v_mul_u32_u24 v6, 5, v5
    v_sub_u32 v4, v4, v6
    v_bfe_u32 v6, v5, 5, 2
    v_mul_u32_u24 v6, 448, v6
    v_lshrrev_b32 v7, 7, v5
    v_lshl_add_u32 v6, v7, 5, v6
    v_and_b32 v5, 31, v5
    v_add_u32 v6, v6, v5
    v_mul_u32_u24 v6, 1280, v6
    v_cmp_gt_u32 vcc, 14, v7
    v_lshl_add_u32 v25, v4, 7, v6
    v_mov_b32 v5, 1073741824
    v_cndmask_b32 v25, v5, v25, vcc
    s_bfe_u32 s64, s6, 0x40018
    s_lshl_b32 s64, s64, 10
    v_add_u32 v4, s64, v3
    v_mul_lo_u32 v5, v4, s74
    v_lshrrev_b32 v5, 18, v5
    v_mul_u32_u24 v6, 5, v5
    v_sub_u32 v4, v4, v6
    v_bfe_u32 v6, v5, 5, 2
    v_mul_u32_u24 v6, 448, v6
    v_lshrrev_b32 v7, 7, v5
    v_lshl_add_u32 v6, v7, 5, v6
    v_and_b32 v5, 31, v5
    v_add_u32 v6, v6, v5
    v_mul_u32_u24 v6, 1280, v6
    v_cmp_gt_u32 vcc, 14, v7
    v_lshl_add_u32 v26, v4, 7, v6
    v_mov_b32 v5, 1073741824
    v_cndmask_b32 v26, v5, v26, vcc
    v_readfirstlane_b32 s64, v20
    s_nop 4
    buffer_load_dword v30, off, s[24:27], s64
    s_waitcnt vmcnt(0)
    buffer_load_dword v30, v16, s[8:11], s67 offen
    s_waitcnt vmcnt(1)
    buffer_load_dword v30, v17, s[8:11], s67 offen
    s_waitcnt vmcnt(1)
    buffer_load_dword v30, v20, s[24:27], s66 offen
    s_waitcnt vmcnt(1)
    buffer_load_dword v30, v21, s[24:27], s66 offen
    s_waitcnt vmcnt(1)
    buffer_load_dword v30, v22, s[24:27], s66 offen
    s_waitcnt vmcnt(1)
    buffer_load_dword v30, v23, s[24:27], s66 offen
    s_waitcnt vmcnt(1)
    buffer_load_dword v30, v24, s[24:27], s66 offen
    s_waitcnt vmcnt(1)
    buffer_load_dword v30, v25, s[24:27], s66 offen
    s_waitcnt vmcnt(1)
    buffer_load_dword v30, v26, s[24:27], s66 offen
    s_waitcnt vmcnt(1)
    s_waitcnt vmcnt(0)
    s_branch L_fin
L_code_end:
.section .rodata,"a"
.p2align 6
.amdhsa_kernel standalone__dense_activation_gelu__prompt_kernel
  .amdhsa_next_free_vgpr 512
  .amdhsa_next_free_sgpr 102
  .amdhsa_accum_offset 256
  .amdhsa_group_segment_fixed_size 0
  .amdhsa_kernarg_size 64
  .amdhsa_user_sgpr_count 2
  .amdhsa_user_sgpr_kernarg_segment_ptr 1
  .amdhsa_system_sgpr_workgroup_id_x 1
.end_amdhsa_kernel
```
